```python
import torch

def _softmax(x, axis=-1):
    return torch.softmax(x, dim=axis)
def _gelu(x):
    return torch.nn.functional.gelu(x, approximate="tanh")
def _silu(x):
    return torch.nn.functional.silu(x)
def _sigmoid(x):
    return torch.sigmoid(x)
def _layernorm(x, axis=-1, eps=1e-5):
    m = x.mean(dim=axis, keepdim=True)
    v = x.var(dim=axis, keepdim=True, unbiased=False)
    return (x - m) / torch.sqrt(v + eps)
def _scatter_add(tgt, idx, src, axis=0):
    return tgt.clone().index_add_(axis, idx, src)
def _segment_sum(src, seg, n):
    out = torch.zeros((n,) + src.shape[1:], dtype=src.dtype)
    return out.index_add_(0, seg, src)
def _pad(x, pw):
    flat = tuple(v for pair in reversed(pw) for v in pair)
    return torch.nn.functional.pad(x, flat)

kernel_name = 'concat_heads__mha_block__mha_block__prompt'

def setup_inputs():

    _w = (lambda a: (lambda t: t.to(torch.bfloat16) if t.is_floating_point() else t)(torch.as_tensor(a)))
    def _A_setup():
        B, S, D, H = 1, 2048, 640, 32
        return {
            "x": _w((lambda *s: torch.randn(*s, dtype=torch.bfloat16) * 0.2)(B, S, D)),
            "wqkv": _w((lambda *s: torch.randn(*s, dtype=torch.bfloat16) * 0.2)(D, 3 * D)),
            "wo": _w((lambda *s: torch.randn(*s, dtype=torch.bfloat16) * 0.05)(D, D)),
        }
    _A_in = _A_setup()

    def _B_setup():
        B, S, D, H = 1, 2048, 640, 32
        return {
            "x": _w((lambda *s: torch.randn(*s, dtype=torch.bfloat16) * 0.2)(B, S, D)),
            "wqkv": _w((lambda *s: torch.randn(*s, dtype=torch.bfloat16) * 0.2)(D, 3 * D)),
            "wo": _w((lambda *s: torch.randn(*s, dtype=torch.bfloat16) * 0.05)(D, D)),
        }
    _B_in = _B_setup()

    return {
        "A_x": _A_in["x"],
        "A_wqkv": _A_in["wqkv"],
        "A_wo": _A_in["wo"],
        "B_x": _B_in["x"],
        "B_wqkv": _B_in["wqkv"],
        "B_wo": _B_in["wo"],
    }

def reference(A_x, A_wqkv, A_wo, B_x, B_wqkv, B_wo):
    def _A_ref(x, wqkv, wo):
        B, S, D = x.shape
        H = 32
        Dh = D // H
        qkv = (lambda x, *d: x.permute(*d))((x @ wqkv).reshape(B, S, 3, H, Dh), 2, 0, 3, 1, 4)
        q, k, v = qkv[0], qkv[1], qkv[2]
        scores = torch.einsum("bhqd,bhkd->bhqk", q, k) * (Dh ** -0.5)
        p = _softmax(scores, axis=-1)
        o = torch.einsum("bhqk,bhkd->bhqd", p, v)
        return (lambda x, *d: x.permute(*d))(o, 0, 2, 1, 3).reshape(B, S, D) @ wo

    def _B_ref(x, wqkv, wo):
        B, S, D = x.shape
        H = 32
        Dh = D // H
        qkv = (lambda x, *d: x.permute(*d))((x @ wqkv).reshape(B, S, 3, H, Dh), 2, 0, 3, 1, 4)
        q, k, v = qkv[0], qkv[1], qkv[2]
        scores = torch.einsum("bhqd,bhkd->bhqk", q, k) * (Dh ** -0.5)
        p = _softmax(scores, axis=-1)
        o = torch.einsum("bhqk,bhkd->bhqd", p, v)
        return (lambda x, *d: x.permute(*d))(o, 0, 2, 1, 3).reshape(B, S, D) @ wo

    a = _A_ref(A_x, A_wqkv, A_wo)
    b = _B_ref(B_x, B_wqkv, B_wo)
    return torch.concatenate([a, b], axis=-1)
```

```asm
; @launch grid=(256,1,1) block=(576,1,1) lds=157184
.amdgcn_target "amdgcn-amd-amdhsa--gfx950"
.text
.globl concat_heads__mha_block__mha_block__prompt_kernel
.p2align 8
.type concat_heads__mha_block__mha_block__prompt_kernel,@function
concat_heads__mha_block__mha_block__prompt_kernel:
    s_cmp_ge_u32 s2, 256
    s_cbranch_scc1 concat_heads__mha_block__mha_block__prompt_kernel_done
    s_bfe_u32 s33, s2, 0x10002
    s_load_dwordx4 s[28:31], s[0:1], 48
    s_load_dwordx2 s[6:7], s[0:1], 64
    s_mul_i32 s37, s33, 24
    s_add_u32 s0, s0, s37
    s_addc_u32 s1, s1, 0
    s_load_dwordx4 s[8:11], s[0:1], 0
    s_load_dwordx2 s[24:25], s[0:1], 16
    s_getpc_b64 s[48:49]
concat_heads__mha_block__mha_block__prompt_kernel_pc:
    s_sub_u32 s48, s48, concat_heads__mha_block__mha_block__prompt_kernel_pc - concat_heads__mha_block__mha_block__prompt_kernel
    s_subb_u32 s49, s49, 0
    v_subrev_u32 v8, 0, v0
    v_cmp_gt_u32 vcc, 8, v8
    s_lshr_b32 s36, s2, 3
    v_lshlrev_b32 v8, 5, v8
    v_add_u32 v8, s36, v8
    v_lshlrev_b32 v8, 7, v8
    v_min_u32 v8, concat_heads__mha_block__mha_block__prompt_kernel_end - concat_heads__mha_block__mha_block__prompt_kernel - 4, v8
    s_and_saveexec_b64 s[50:51], vcc
    s_cbranch_execz concat_heads__mha_block__mha_block__prompt_kernel_nc
    global_load_dword v167, v8, s[48:49]
concat_heads__mha_block__mha_block__prompt_kernel_nc:
    s_mov_b64 exec, s[50:51]
    v_lshrrev_b32 v2, 6, v0
    v_and_b32 v1, 63, v0
    s_lshr_b32 s36, s2, 3
    v_readfirstlane_b32 s32, v2
    s_and_b32 s34, s36, 7
    s_lshr_b32 s35, s36, 3
    s_mul_i32 s3, s35, 3
    s_add_u32 s3, s3, s34
    s_cmp_ge_u32 s3, 10
    s_cselect_b32 s36, 10, 0
    s_sub_u32 s3, s3, s36
    s_mov_b32 s3, 0
    s_and_b32 s36, s2, 1
    s_lshl_b32 s36, s36, 3
    s_add_u32 s34, s34, s36
    s_and_b32 s36, s2, 2
    s_lshl_b32 s36, s36, 1
    s_add_u32 s35, s35, s36
    s_mov_b32 s42, 0
    s_mov_b32 s43, -1
    s_bfe_u32 s5, s2, 0x30003
    s_and_b32 s4, s2, 1
    s_lshl_b32 s4, s4, 2
    s_and_b32 s36, s2, 2
    s_add_u32 s4, s4, s36
    s_lshl_b32 s4, s4, 1
    s_lshr_b32 s36, s2, 6
    s_add_u32 s4, s4, s36
    s_lshl_b32 s36, s33, 3
    s_add_u32 s36, s36, s35
    s_mul_i32 s47, s36, 655360
    s_mul_i32 s38, s35, 160
    s_cmp_ge_u32 s32, 8
    s_cbranch_scc1 concat_heads__mha_block__mha_block__prompt_kernel_helper
    s_lshl_b32 s36, s34, 7
    s_lshl_b32 s37, s32, 3
    s_add_u32 s36, s36, s37
    v_lshrrev_b32 v2, 3, v1
    v_add_u32 v2, s36, v2
    v_mul_u32_u24 v2, 1280, v2
    s_and_b32 s36, s32, 1
    s_lshl_b32 s36, s36, 2
    v_lshrrev_b32 v3, 4, v1
    v_add_u32 v4, s36, v3
    v_and_b32 v5, 7, v1
    v_xor_b32 v4, v4, v5
    v_lshl_add_u32 v60, v4, 4, v2
    s_lshl_b32 s39, s32, 10
    s_lshl_b32 s53, s3, 7
    s_mul_i32 s54, s3, 245760
    s_add_u32 s37, s32, 8
    s_cmp_eq_u32 s32, 7
    s_cselect_b32 s37, 7, s37
    s_lshl_b32 s40, s37, 10
    s_lshr_b32 s36, s39, 4
    v_add_u32 v2, s36, v1
    v_mul_u32_u24 v3, 2185, v2
    v_lshrrev_b32 v3, 16, v3
    v_mul_u32_u24 v4, 30, v3
    v_sub_u32 v2, v2, v4
    v_and_b32 v4, 0x13, v3
    v_bfe_u32 v5, v3, 2, 1
    v_lshl_or_b32 v4, v5, 3, v4
    v_bfe_u32 v5, v3, 3, 1
    v_lshl_or_b32 v4, v5, 2, v4
    v_mul_u32_u24 v4, 3840, v4
    v_mul_u32_u24 v3, 26, v2
    v_lshrrev_b32 v3, 8, v3
    v_mul_u32_u24 v3, 1120, v3
    v_lshl_add_u32 v2, v2, 4, v3
    v_add3_u32 v61, v2, v4, s38
    s_lshr_b32 s36, s40, 4
    v_add_u32 v2, s36, v1
    v_mul_u32_u24 v3, 2185, v2
    v_lshrrev_b32 v3, 16, v3
    v_mul_u32_u24 v4, 30, v3
    v_sub_u32 v2, v2, v4
    v_and_b32 v4, 0x13, v3
    v_bfe_u32 v5, v3, 2, 1
    v_lshl_or_b32 v4, v5, 3, v4
    v_bfe_u32 v5, v3, 3, 1
    v_lshl_or_b32 v4, v5, 2, v4
    v_mul_u32_u24 v4, 3840, v4
    v_mul_u32_u24 v3, 26, v2
    v_lshrrev_b32 v3, 8, v3
    v_mul_u32_u24 v3, 1120, v3
    v_lshl_add_u32 v2, v2, 4, v3
    v_add3_u32 v62, v2, v4, s38
    s_waitcnt lgkmcnt(0)
    s_mov_b32 s12, s10
    s_mov_b32 s13, s11
    s_mov_b32 s20, s30
    s_mov_b32 s21, s31
    s_mov_b32 s16, s6
    s_mov_b32 s17, s7
    s_mov_b32 s10, 2621440
    s_mov_b32 s11, 0x20000
    s_mov_b32 s14, 2457600
    s_mov_b32 s15, 0x20000
    s_mov_b32 s18, 15806720
    s_mov_b32 s19, 0x20000
    s_mov_b32 s22, 256
    s_mov_b32 s23, 0x20000
    s_mov_b32 s26, 819200
    s_mov_b32 s27, 0x20000
    s_mov_b32 s30, 5242880
    s_mov_b32 s31, 0x20000
    s_lshl_b32 s55, s33, 7
    s_add_u32 s55, s55, 15740928
    s_load_dword s61, s[6:7], s55
    s_mov_b32 m0, s39
    s_add_u32 s36, s53, 81920
    buffer_load_dwordx4 v60, s[8:11], s53 offen lds
    s_add_u32 m0, s39, 8192
    s_nop 0
    buffer_load_dwordx4 v60, s[8:11], s36 offen lds
    s_add_u32 m0, s39, 16384
    s_add_u32 s36, s54, 0
    buffer_load_dwordx4 v61, s[12:15], s36 offen lds
    s_add_u32 m0, s39, 31744
    s_add_u32 s36, s54, 122880
    buffer_load_dwordx4 v61, s[12:15], s36 offen lds
    s_add_u32 m0, s40, 16384
    s_add_u32 s36, s54, 0
    buffer_load_dwordx4 v62, s[12:15], s36 offen lds
    s_add_u32 m0, s40, 31744
    s_add_u32 s36, s54, 122880
    buffer_load_dwordx4 v62, s[12:15], s36 offen lds
    s_barrier
    s_and_b32 s36, s32, 3
    s_lshl_b32 s36, s36, 5
    v_and_b32 v2, 15, v1
    v_lshrrev_b32 v3, 4, v1
    v_lshrrev_b32 v4, 1, v2
    v_xor_b32 v4, v4, v3
    v_add_u32 v2, s36, v2
    v_lshlrev_b32 v2, 7, v2
    v_lshl_add_u32 v25, v4, 4, v2
    v_xor_b32 v26, 64, v25
    v_lshrrev_b32 v2, 5, v1
    v_lshlrev_b32 v2, 4, v2
    v_bfe_u32 v4, v1, 4, 1
    v_lshl_add_u32 v2, v4, 2, v2
    v_bfe_u32 v4, v1, 2, 2
    v_add_u32 v2, v2, v4
    v_mul_u32_u24 v2, 480, v2
    v_add_u32 v7, 16384, v2
    v_bfe_u32 v4, v1, 1, 1
    v_mul_u32_u24 v4, 40, v4
    v_and_b32 v5, 1, v1
    v_lshl_add_u32 v4, v5, 4, v4
    v_add_u32 v31, v7, v4
    s_cmp_ge_u32 s32, 4
    s_cselect_b32 s36, 8, 40
    v_and_b32 v4, 3, v1
    v_mad_u32_u24 v34, v4, s36, v7
    v_add_u32 v27, 47104, v25
    v_add_u32 v28, 47104, v26
    v_add_u32 v32, 47104, v31
    v_add_u32 v35, 47104, v34
    v_add_u32 v29, 94208, v25
    v_add_u32 v30, 94208, v26
    v_add_u32 v33, 94208, v31
    v_add_u32 v36, 94208, v34
    s_lshr_b32 s36, s32, 1
    s_mul_i32 s37, s36, 10240
    v_lshlrev_b32 v17, 4, v1
    v_lshlrev_b32 v2, 3, v1
    v_add_u32 v2, 1024, v2
    v_mov_b32 v3, 1073741824
    v_cndmask_b32_e64 v18, v2, v3, s[42:43]
    v_add_u32 v12, s37, v17
    v_add_u32 v2, s37, v2
    v_mov_b32 v3, 123008
    v_cndmask_b32_e64 v13, v2, v3, s[42:43]
    v_cndmask_b32_e64 v15, 1, 0, s[42:43]
    v_and_b32 v4, 31, v1
    v_lshrrev_b32 v5, 5, v1
    v_mul_u32_u24 v5, 320, v5
    v_lshl_add_u32 v5, v4, 4, v5
    s_add_u32 s38, s37, 1280
    v_add_u32 v5, s38, v5
    v_cmp_gt_u32 vcc, 20, v4
    v_mov_b32 v8, 0xdddddddd
    v_mov_b32 v9, v12
    v_cndmask_b32 v14, v3, v5, vcc
    v_cndmask_b32_e64 v16, 0, 1, vcc
    v_cmp_lt_u32 vcc, 20, v4
    v_add_u32 v5, 16, v3
    v_mov_b32 v10, v13
    v_cndmask_b32 v14, v14, v5, vcc
    v_mov_b32 v11, v14
    s_mul_i32 s37, s32, 2560
    s_add_u32 s37, s37, 131584
    v_add_u32 v19, s37, v17
    v_and_b32 v20, 31, v1
    v_lshlrev_b32 v20, 3, v20
    s_add_u32 s37, s37, 1024
    v_add_u32 v20, s37, v20
    s_lshl_b32 s37, s33, 4
    s_add_u32 s37, s37, s34
    s_lshl_b32 s37, s37, 1
    s_and_b32 s38, s32, 1
    s_add_u32 s37, s37, s38
    s_lshl_b32 s37, s37, 5
    s_lshl_b32 s38, s35, 2
    s_add_u32 s37, s37, s38
    s_add_u32 s37, s37, s36
    s_mul_i32 s46, s37, 2560
    s_add_u32 s46, s46, 10485760
    s_mov_b32 s57, s47
    s_mul_i32 s36, s36, 163840
    s_add_u32 s47, s47, s36
    s_and_b32 s36, s32, 3
    s_mul_i32 s37, s36, 10240
    v_add_u32 v21, s37, v17
    s_mul_i32 s36, s36, 163840
    s_mul_i32 s37, s34, 10240
    s_add_u32 s36, s36, s37
    s_add_u32 s56, s36, s57
    v_mov_b32 v92, 0
    v_mov_b32 v93, 0
    v_mov_b32 v94, 0
    v_mov_b32 v95, 0
    v_mov_b32 v96, 0
    v_mov_b32 v97, 0
    v_mov_b32 v98, 0
    v_mov_b32 v99, 0
    v_mov_b32 v100, 0
    v_mov_b32 v101, 0
    v_mov_b32 v102, 0
    v_mov_b32 v103, 0
    v_mov_b32 v104, 0
    v_mov_b32 v105, 0
    v_mov_b32 v106, 0
    v_mov_b32 v107, 0
    v_mov_b32 v108, 0
    v_mov_b32 v109, 0
    v_mov_b32 v110, 0
    v_mov_b32 v111, 0
    v_mov_b32 v112, 0
    v_mov_b32 v113, 0
    v_mov_b32 v114, 0
    v_mov_b32 v115, 0
    v_mov_b32 v116, 0
    v_mov_b32 v117, 0
    v_mov_b32 v118, 0
    v_mov_b32 v119, 0
    v_mov_b32 v120, 0
    v_mov_b32 v121, 0
    v_mov_b32 v122, 0
    v_mov_b32 v123, 0
    v_mov_b32 v124, 0
    v_mov_b32 v125, 0
    v_mov_b32 v126, 0
    v_mov_b32 v127, 0
    v_mov_b32 v128, 0
    v_mov_b32 v129, 0
    v_mov_b32 v130, 0
    v_mov_b32 v131, 0
    v_mov_b32 v132, 0
    v_mov_b32 v133, 0
    v_mov_b32 v134, 0
    v_mov_b32 v135, 0
    v_mov_b32 v136, 0
    v_mov_b32 v137, 0
    v_mov_b32 v138, 0
    v_mov_b32 v139, 0
    v_mov_b32 v140, 0
    v_mov_b32 v141, 0
    v_mov_b32 v142, 0
    v_mov_b32 v143, 0
    v_mov_b32 v144, 0
    v_mov_b32 v145, 0
    v_mov_b32 v146, 0
    v_mov_b32 v147, 0
    v_mov_b32 v148, 0
    v_mov_b32 v149, 0
    v_mov_b32 v150, 0
    v_mov_b32 v151, 0
    v_mov_b32 v152, 0
    v_mov_b32 v153, 0
    v_mov_b32 v154, 0
    v_mov_b32 v155, 0
    s_mov_b32 s58, 1051011932
    s_mov_b32 s59, 1051011932
    s_and_b32 s38, s32, 3
    v_and_b32 v2, 15, v1
    v_lshrrev_b32 v3, 4, v1
    v_lshrrev_b32 v4, 2, v2
    v_and_b32 v5, 3, v2
    v_lshl_add_u32 v6, v4, 3, v5
    v_lshrrev_b32 v4, 1, v3
    v_and_b32 v5, 1, v3
    s_mul_i32 s36, s38, 2560
    v_mul_u32_u24 v37, 10240, v4
    v_lshl_add_u32 v37, v5, 9, v37
    v_lshl_add_u32 v37, v6, 4, v37
    v_add_u32 v37, s36, v37
    s_cmp_ge_u32 s32, 4
    s_cbranch_scc1 concat_heads__mha_block__mha_block__prompt_kernel_p1b
    s_add_u32 s37, s36, 1024
    v_mul_u32_u24 v38, 10240, v3
    v_lshl_add_u32 v38, v6, 3, v38
    v_add_u32 v38, s37, v38
    s_mul_i32 s36, s38, 1280
    s_add_u32 s36, s36, 131584
    v_mul_u32_u24 v39, 5120, v4
    v_lshl_add_u32 v39, v5, 9, v39
    v_lshl_add_u32 v39, v2, 4, v39
    v_add_u32 v39, s36, v39
    s_add_u32 s36, s36, 1024
    v_mul_u32_u24 v40, 5120, v3
    v_lshl_add_u32 v40, v2, 3, v40
    v_add_u32 v40, s36, v40
    s_waitcnt vmcnt(0) lgkmcnt(0)
    s_barrier
    s_add_u32 s61, s61, 2654435769
    ds_read_b128 v[44:47], v25 offset:0
    ds_read_b128 v[48:51], v25 offset:2048
    ds_read_b64_tr_b16 v[60:61], v31 offset:0
    ds_read_b64_tr_b16 v[62:63], v31 offset:3840
    ds_read_b64_tr_b16 v[64:65], v31 offset:8
    ds_read_b64_tr_b16 v[66:67], v31 offset:3848
    ds_read_b64_tr_b16 v[68:69], v31 offset:80
    ds_read_b64_tr_b16 v[70:71], v31 offset:3920
    ds_read_b64_tr_b16 v[72:73], v31 offset:88
    ds_read_b64_tr_b16 v[74:75], v31 offset:3928
    ds_read_b64_tr_b16 v[76:77], v34 offset:32
    ds_read_b64_tr_b16 v[78:79], v34 offset:3872
    ds_read_b64_tr_b16 v[80:81], v31 offset:160
    ds_read_b64_tr_b16 v[82:83], v31 offset:4000
    ds_read_b64_tr_b16 v[84:85], v31 offset:168
    ds_read_b64_tr_b16 v[86:87], v31 offset:4008
    ds_read_b64_tr_b16 v[88:89], v34 offset:192
    ds_read_b64_tr_b16 v[90:91], v34 offset:4032
    s_waitcnt lgkmcnt(8)
    ds_read_b128 v[52:55], v26 offset:0
    ds_read_b128 v[56:59], v26 offset:2048
    v_mfma_f32_16x16x32_bf16 v[92:95], v[60:63], v[44:47], v[92:95]
    v_mfma_f32_16x16x32_bf16 v[96:99], v[60:63], v[48:51], v[96:99]
    ds_read_b64_tr_b16 v[60:61], v31 offset:15360
    ds_read_b64_tr_b16 v[62:63], v31 offset:19200
    v_mfma_f32_16x16x32_bf16 v[100:103], v[64:67], v[44:47], v[100:103]
    v_mfma_f32_16x16x32_bf16 v[104:107], v[64:67], v[48:51], v[104:107]
    ds_read_b64_tr_b16 v[64:65], v31 offset:15368
    ds_read_b64_tr_b16 v[66:67], v31 offset:19208
    v_mfma_f32_16x16x32_bf16 v[108:111], v[68:71], v[44:47], v[108:111]
    v_mfma_f32_16x16x32_bf16 v[112:115], v[68:71], v[48:51], v[112:115]
    ds_read_b64_tr_b16 v[68:69], v31 offset:15440
    ds_read_b64_tr_b16 v[70:71], v31 offset:19280
    v_mfma_f32_16x16x32_bf16 v[116:119], v[72:75], v[44:47], v[116:119]
    v_mfma_f32_16x16x32_bf16 v[120:123], v[72:75], v[48:51], v[120:123]
    ds_read_b64_tr_b16 v[72:73], v31 offset:15448
    ds_read_b64_tr_b16 v[74:75], v31 offset:19288
    s_waitcnt lgkmcnt(10)
    v_mfma_f32_16x16x32_bf16 v[124:127], v[76:79], v[44:47], v[124:127]
    v_mfma_f32_16x16x32_bf16 v[128:131], v[76:79], v[48:51], v[128:131]
    ds_read_b64_tr_b16 v[76:77], v34 offset:15392
    ds_read_b64_tr_b16 v[78:79], v34 offset:19232
    v_mfma_f32_16x16x32_bf16 v[132:135], v[80:83], v[44:47], v[132:135]
    v_mfma_f32_16x16x32_bf16 v[136:139], v[80:83], v[48:51], v[136:139]
    ds_read_b64_tr_b16 v[80:81], v31 offset:15520
    ds_read_b64_tr_b16 v[82:83], v31 offset:19360
    v_mfma_f32_16x16x32_bf16 v[140:143], v[84:87], v[44:47], v[140:143]
    v_mfma_f32_16x16x32_bf16 v[144:147], v[84:87], v[48:51], v[144:147]
    ds_read_b64_tr_b16 v[84:85], v31 offset:15528
    ds_read_b64_tr_b16 v[86:87], v31 offset:19368
    v_mfma_f32_16x16x32_bf16 v[148:151], v[88:91], v[44:47], v[148:151]
    v_mfma_f32_16x16x32_bf16 v[152:155], v[88:91], v[48:51], v[152:155]
    ds_read_b64_tr_b16 v[88:89], v34 offset:15552
    ds_read_b64_tr_b16 v[90:91], v34 offset:19392
    s_waitcnt lgkmcnt(0)
    s_barrier
    ds_read_b128 v[44:47], v27 offset:0
    ds_read_b128 v[48:51], v27 offset:2048
    v_mfma_f32_16x16x32_bf16 v[92:95], v[60:63], v[52:55], v[92:95]
    v_mfma_f32_16x16x32_bf16 v[96:99], v[60:63], v[56:59], v[96:99]
    ds_read_b64_tr_b16 v[60:61], v32 offset:0
    ds_read_b64_tr_b16 v[62:63], v32 offset:3840
    v_mfma_f32_16x16x32_bf16 v[100:103], v[64:67], v[52:55], v[100:103]
    v_mfma_f32_16x16x32_bf16 v[104:107], v[64:67], v[56:59], v[104:107]
    ds_read_b64_tr_b16 v[64:65], v32 offset:8
    ds_read_b64_tr_b16 v[66:67], v32 offset:3848
    v_mfma_f32_16x16x32_bf16 v[108:111], v[68:71], v[52:55], v[108:111]
    v_mfma_f32_16x16x32_bf16 v[112:115], v[68:71], v[56:59], v[112:115]
    ds_read_b64_tr_b16 v[68:69], v32 offset:80
    ds_read_b64_tr_b16 v[70:71], v32 offset:3920
    v_mfma_f32_16x16x32_bf16 v[116:119], v[72:75], v[52:55], v[116:119]
    v_mfma_f32_16x16x32_bf16 v[120:123], v[72:75], v[56:59], v[120:123]
    ds_read_b64_tr_b16 v[72:73], v32 offset:88
    ds_read_b64_tr_b16 v[74:75], v32 offset:3928
    v_mfma_f32_16x16x32_bf16 v[124:127], v[76:79], v[52:55], v[124:127]
    v_mfma_f32_16x16x32_bf16 v[128:131], v[76:79], v[56:59], v[128:131]
    ds_read_b64_tr_b16 v[76:77], v35 offset:32
    ds_read_b64_tr_b16 v[78:79], v35 offset:3872
    v_mfma_f32_16x16x32_bf16 v[132:135], v[80:83], v[52:55], v[132:135]
    v_mfma_f32_16x16x32_bf16 v[136:139], v[80:83], v[56:59], v[136:139]
    ds_read_b64_tr_b16 v[80:81], v32 offset:160
    ds_read_b64_tr_b16 v[82:83], v32 offset:4000
    v_mfma_f32_16x16x32_bf16 v[140:143], v[84:87], v[52:55], v[140:143]
    v_mfma_f32_16x16x32_bf16 v[144:147], v[84:87], v[56:59], v[144:147]
    ds_read_b64_tr_b16 v[84:85], v32 offset:168
    ds_read_b64_tr_b16 v[86:87], v32 offset:4008
    v_mfma_f32_16x16x32_bf16 v[148:151], v[88:91], v[52:55], v[148:151]
    v_mfma_f32_16x16x32_bf16 v[152:155], v[88:91], v[56:59], v[152:155]
    ds_read_b64_tr_b16 v[88:89], v35 offset:192
    ds_read_b64_tr_b16 v[90:91], v35 offset:4032
    s_waitcnt lgkmcnt(8)
    ds_read_b128 v[52:55], v28 offset:0
    ds_read_b128 v[56:59], v28 offset:2048
    v_mfma_f32_16x16x32_bf16 v[92:95], v[60:63], v[44:47], v[92:95]
    v_mfma_f32_16x16x32_bf16 v[96:99], v[60:63], v[48:51], v[96:99]
    ds_read_b64_tr_b16 v[60:61], v32 offset:15360
    ds_read_b64_tr_b16 v[62:63], v32 offset:19200
    v_mfma_f32_16x16x32_bf16 v[100:103], v[64:67], v[44:47], v[100:103]
    v_mfma_f32_16x16x32_bf16 v[104:107], v[64:67], v[48:51], v[104:107]
    ds_read_b64_tr_b16 v[64:65], v32 offset:15368
    ds_read_b64_tr_b16 v[66:67], v32 offset:19208
    v_mfma_f32_16x16x32_bf16 v[108:111], v[68:71], v[44:47], v[108:111]
    v_mfma_f32_16x16x32_bf16 v[112:115], v[68:71], v[48:51], v[112:115]
    ds_read_b64_tr_b16 v[68:69], v32 offset:15440
    ds_read_b64_tr_b16 v[70:71], v32 offset:19280
    v_mfma_f32_16x16x32_bf16 v[116:119], v[72:75], v[44:47], v[116:119]
    v_mfma_f32_16x16x32_bf16 v[120:123], v[72:75], v[48:51], v[120:123]
    ds_read_b64_tr_b16 v[72:73], v32 offset:15448
    ds_read_b64_tr_b16 v[74:75], v32 offset:19288
    s_waitcnt lgkmcnt(10)
    v_mfma_f32_16x16x32_bf16 v[124:127], v[76:79], v[44:47], v[124:127]
    v_mfma_f32_16x16x32_bf16 v[128:131], v[76:79], v[48:51], v[128:131]
    ds_read_b64_tr_b16 v[76:77], v35 offset:15392
    ds_read_b64_tr_b16 v[78:79], v35 offset:19232
    v_mfma_f32_16x16x32_bf16 v[132:135], v[80:83], v[44:47], v[132:135]
    v_mfma_f32_16x16x32_bf16 v[136:139], v[80:83], v[48:51], v[136:139]
    ds_read_b64_tr_b16 v[80:81], v32 offset:15520
    ds_read_b64_tr_b16 v[82:83], v32 offset:19360
    v_mfma_f32_16x16x32_bf16 v[140:143], v[84:87], v[44:47], v[140:143]
    v_mfma_f32_16x16x32_bf16 v[144:147], v[84:87], v[48:51], v[144:147]
    ds_read_b64_tr_b16 v[84:85], v32 offset:15528
    ds_read_b64_tr_b16 v[86:87], v32 offset:19368
    v_mfma_f32_16x16x32_bf16 v[148:151], v[88:91], v[44:47], v[148:151]
    v_mfma_f32_16x16x32_bf16 v[152:155], v[88:91], v[48:51], v[152:155]
    ds_read_b64_tr_b16 v[88:89], v35 offset:15552
    ds_read_b64_tr_b16 v[90:91], v35 offset:19392
    s_waitcnt lgkmcnt(0)
    s_barrier
    ds_read_b128 v[44:47], v29 offset:0
    ds_read_b128 v[48:51], v29 offset:2048
    v_mfma_f32_16x16x32_bf16 v[92:95], v[60:63], v[52:55], v[92:95]
    v_mfma_f32_16x16x32_bf16 v[96:99], v[60:63], v[56:59], v[96:99]
    ds_read_b64_tr_b16 v[60:61], v33 offset:0
    ds_read_b64_tr_b16 v[62:63], v33 offset:3840
    v_mfma_f32_16x16x32_bf16 v[100:103], v[64:67], v[52:55], v[100:103]
    v_mfma_f32_16x16x32_bf16 v[104:107], v[64:67], v[56:59], v[104:107]
    ds_read_b64_tr_b16 v[64:65], v33 offset:8
    ds_read_b64_tr_b16 v[66:67], v33 offset:3848
    v_mfma_f32_16x16x32_bf16 v[108:111], v[68:71], v[52:55], v[108:111]
    v_mfma_f32_16x16x32_bf16 v[112:115], v[68:71], v[56:59], v[112:115]
    ds_read_b64_tr_b16 v[68:69], v33 offset:80
    ds_read_b64_tr_b16 v[70:71], v33 offset:3920
    v_mfma_f32_16x16x32_bf16 v[116:119], v[72:75], v[52:55], v[116:119]
    v_mfma_f32_16x16x32_bf16 v[120:123], v[72:75], v[56:59], v[120:123]
    ds_read_b64_tr_b16 v[72:73], v33 offset:88
    ds_read_b64_tr_b16 v[74:75], v33 offset:3928
    v_mfma_f32_16x16x32_bf16 v[124:127], v[76:79], v[52:55], v[124:127]
    v_mfma_f32_16x16x32_bf16 v[128:131], v[76:79], v[56:59], v[128:131]
    ds_read_b64_tr_b16 v[76:77], v36 offset:32
    ds_read_b64_tr_b16 v[78:79], v36 offset:3872
    v_mfma_f32_16x16x32_bf16 v[132:135], v[80:83], v[52:55], v[132:135]
    v_mfma_f32_16x16x32_bf16 v[136:139], v[80:83], v[56:59], v[136:139]
    ds_read_b64_tr_b16 v[80:81], v33 offset:160
    ds_read_b64_tr_b16 v[82:83], v33 offset:4000
    v_mfma_f32_16x16x32_bf16 v[140:143], v[84:87], v[52:55], v[140:143]
    v_mfma_f32_16x16x32_bf16 v[144:147], v[84:87], v[56:59], v[144:147]
    ds_read_b64_tr_b16 v[84:85], v33 offset:168
    ds_read_b64_tr_b16 v[86:87], v33 offset:4008
    v_mfma_f32_16x16x32_bf16 v[148:151], v[88:91], v[52:55], v[148:151]
    v_mfma_f32_16x16x32_bf16 v[152:155], v[88:91], v[56:59], v[152:155]
    ds_read_b64_tr_b16 v[88:89], v36 offset:192
    ds_read_b64_tr_b16 v[90:91], v36 offset:4032
    s_waitcnt lgkmcnt(8)
    ds_read_b128 v[52:55], v30 offset:0
    ds_read_b128 v[56:59], v30 offset:2048
    v_mfma_f32_16x16x32_bf16 v[92:95], v[60:63], v[44:47], v[92:95]
    v_mfma_f32_16x16x32_bf16 v[96:99], v[60:63], v[48:51], v[96:99]
    ds_read_b64_tr_b16 v[60:61], v33 offset:15360
    ds_read_b64_tr_b16 v[62:63], v33 offset:19200
    v_mfma_f32_16x16x32_bf16 v[100:103], v[64:67], v[44:47], v[100:103]
    v_mfma_f32_16x16x32_bf16 v[104:107], v[64:67], v[48:51], v[104:107]
    ds_read_b64_tr_b16 v[64:65], v33 offset:15368
    ds_read_b64_tr_b16 v[66:67], v33 offset:19208
    v_mfma_f32_16x16x32_bf16 v[108:111], v[68:71], v[44:47], v[108:111]
    v_mfma_f32_16x16x32_bf16 v[112:115], v[68:71], v[48:51], v[112:115]
    ds_read_b64_tr_b16 v[68:69], v33 offset:15440
    ds_read_b64_tr_b16 v[70:71], v33 offset:19280
    v_mfma_f32_16x16x32_bf16 v[116:119], v[72:75], v[44:47], v[116:119]
    v_mfma_f32_16x16x32_bf16 v[120:123], v[72:75], v[48:51], v[120:123]
    ds_read_b64_tr_b16 v[72:73], v33 offset:15448
    ds_read_b64_tr_b16 v[74:75], v33 offset:19288
    s_waitcnt lgkmcnt(10)
    v_mfma_f32_16x16x32_bf16 v[124:127], v[76:79], v[44:47], v[124:127]
    v_mfma_f32_16x16x32_bf16 v[128:131], v[76:79], v[48:51], v[128:131]
    ds_read_b64_tr_b16 v[76:77], v36 offset:15392
    ds_read_b64_tr_b16 v[78:79], v36 offset:19232
    v_mfma_f32_16x16x32_bf16 v[132:135], v[80:83], v[44:47], v[132:135]
    v_mfma_f32_16x16x32_bf16 v[136:139], v[80:83], v[48:51], v[136:139]
    ds_read_b64_tr_b16 v[80:81], v33 offset:15520
    ds_read_b64_tr_b16 v[82:83], v33 offset:19360
    v_mfma_f32_16x16x32_bf16 v[140:143], v[84:87], v[44:47], v[140:143]
    v_mfma_f32_16x16x32_bf16 v[144:147], v[84:87], v[48:51], v[144:147]
    ds_read_b64_tr_b16 v[84:85], v33 offset:15528
    ds_read_b64_tr_b16 v[86:87], v33 offset:19368
    v_mfma_f32_16x16x32_bf16 v[148:151], v[88:91], v[44:47], v[148:151]
    v_mfma_f32_16x16x32_bf16 v[152:155], v[88:91], v[48:51], v[152:155]
    ds_read_b64_tr_b16 v[88:89], v36 offset:15552
    ds_read_b64_tr_b16 v[90:91], v36 offset:19392
    s_waitcnt lgkmcnt(0)
    s_barrier
    ds_read_b128 v[44:47], v25 offset:0
    ds_read_b128 v[48:51], v25 offset:2048
    v_mfma_f32_16x16x32_bf16 v[92:95], v[60:63], v[52:55], v[92:95]
    v_mfma_f32_16x16x32_bf16 v[96:99], v[60:63], v[56:59], v[96:99]
    ds_read_b64_tr_b16 v[60:61], v31 offset:0
    ds_read_b64_tr_b16 v[62:63], v31 offset:3840
    v_mfma_f32_16x16x32_bf16 v[100:103], v[64:67], v[52:55], v[100:103]
    v_mfma_f32_16x16x32_bf16 v[104:107], v[64:67], v[56:59], v[104:107]
    ds_read_b64_tr_b16 v[64:65], v31 offset:8
    ds_read_b64_tr_b16 v[66:67], v31 offset:3848
    v_mfma_f32_16x16x32_bf16 v[108:111], v[68:71], v[52:55], v[108:111]
    v_mfma_f32_16x16x32_bf16 v[112:115], v[68:71], v[56:59], v[112:115]
    ds_read_b64_tr_b16 v[68:69], v31 offset:80
    ds_read_b64_tr_b16 v[70:71], v31 offset:3920
    v_mfma_f32_16x16x32_bf16 v[116:119], v[72:75], v[52:55], v[116:119]
    v_mfma_f32_16x16x32_bf16 v[120:123], v[72:75], v[56:59], v[120:123]
    ds_read_b64_tr_b16 v[72:73], v31 offset:88
    ds_read_b64_tr_b16 v[74:75], v31 offset:3928
    v_mfma_f32_16x16x32_bf16 v[124:127], v[76:79], v[52:55], v[124:127]
    v_mfma_f32_16x16x32_bf16 v[128:131], v[76:79], v[56:59], v[128:131]
    ds_read_b64_tr_b16 v[76:77], v34 offset:32
    ds_read_b64_tr_b16 v[78:79], v34 offset:3872
    v_mfma_f32_16x16x32_bf16 v[132:135], v[80:83], v[52:55], v[132:135]
    v_mfma_f32_16x16x32_bf16 v[136:139], v[80:83], v[56:59], v[136:139]
    ds_read_b64_tr_b16 v[80:81], v31 offset:160
    ds_read_b64_tr_b16 v[82:83], v31 offset:4000
    v_mfma_f32_16x16x32_bf16 v[140:143], v[84:87], v[52:55], v[140:143]
    v_mfma_f32_16x16x32_bf16 v[144:147], v[84:87], v[56:59], v[144:147]
    ds_read_b64_tr_b16 v[84:85], v31 offset:168
    ds_read_b64_tr_b16 v[86:87], v31 offset:4008
    v_mfma_f32_16x16x32_bf16 v[148:151], v[88:91], v[52:55], v[148:151]
    v_mfma_f32_16x16x32_bf16 v[152:155], v[88:91], v[56:59], v[152:155]
    ds_read_b64_tr_b16 v[88:89], v34 offset:192
    ds_read_b64_tr_b16 v[90:91], v34 offset:4032
    s_waitcnt lgkmcnt(8)
    ds_read_b128 v[52:55], v26 offset:0
    ds_read_b128 v[56:59], v26 offset:2048
    v_mfma_f32_16x16x32_bf16 v[92:95], v[60:63], v[44:47], v[92:95]
    v_mfma_f32_16x16x32_bf16 v[96:99], v[60:63], v[48:51], v[96:99]
    ds_read_b64_tr_b16 v[60:61], v31 offset:15360
    ds_read_b64_tr_b16 v[62:63], v31 offset:19200
    v_mfma_f32_16x16x32_bf16 v[100:103], v[64:67], v[44:47], v[100:103]
    v_mfma_f32_16x16x32_bf16 v[104:107], v[64:67], v[48:51], v[104:107]
    ds_read_b64_tr_b16 v[64:65], v31 offset:15368
    ds_read_b64_tr_b16 v[66:67], v31 offset:19208
    v_mfma_f32_16x16x32_bf16 v[108:111], v[68:71], v[44:47], v[108:111]
    v_mfma_f32_16x16x32_bf16 v[112:115], v[68:71], v[48:51], v[112:115]
    ds_read_b64_tr_b16 v[68:69], v31 offset:15440
    ds_read_b64_tr_b16 v[70:71], v31 offset:19280
    v_mfma_f32_16x16x32_bf16 v[116:119], v[72:75], v[44:47], v[116:119]
    v_mfma_f32_16x16x32_bf16 v[120:123], v[72:75], v[48:51], v[120:123]
    ds_read_b64_tr_b16 v[72:73], v31 offset:15448
    ds_read_b64_tr_b16 v[74:75], v31 offset:19288
    s_waitcnt lgkmcnt(10)
    v_mfma_f32_16x16x32_bf16 v[124:127], v[76:79], v[44:47], v[124:127]
    v_mfma_f32_16x16x32_bf16 v[128:131], v[76:79], v[48:51], v[128:131]
    ds_read_b64_tr_b16 v[76:77], v34 offset:15392
    ds_read_b64_tr_b16 v[78:79], v34 offset:19232
    v_mfma_f32_16x16x32_bf16 v[132:135], v[80:83], v[44:47], v[132:135]
    v_mfma_f32_16x16x32_bf16 v[136:139], v[80:83], v[48:51], v[136:139]
    ds_read_b64_tr_b16 v[80:81], v31 offset:15520
    ds_read_b64_tr_b16 v[82:83], v31 offset:19360
    v_mfma_f32_16x16x32_bf16 v[140:143], v[84:87], v[44:47], v[140:143]
    v_mfma_f32_16x16x32_bf16 v[144:147], v[84:87], v[48:51], v[144:147]
    ds_read_b64_tr_b16 v[84:85], v31 offset:15528
    ds_read_b64_tr_b16 v[86:87], v31 offset:19368
    v_mfma_f32_16x16x32_bf16 v[148:151], v[88:91], v[44:47], v[148:151]
    v_mfma_f32_16x16x32_bf16 v[152:155], v[88:91], v[48:51], v[152:155]
    ds_read_b64_tr_b16 v[88:89], v34 offset:15552
    ds_read_b64_tr_b16 v[90:91], v34 offset:19392
    s_waitcnt lgkmcnt(0)
    s_barrier
    ds_read_b128 v[44:47], v27 offset:0
    ds_read_b128 v[48:51], v27 offset:2048
    v_mfma_f32_16x16x32_bf16 v[92:95], v[60:63], v[52:55], v[92:95]
    v_mfma_f32_16x16x32_bf16 v[96:99], v[60:63], v[56:59], v[96:99]
    ds_read_b64_tr_b16 v[60:61], v32 offset:0
    ds_read_b64_tr_b16 v[62:63], v32 offset:3840
    v_mfma_f32_16x16x32_bf16 v[100:103], v[64:67], v[52:55], v[100:103]
    v_mfma_f32_16x16x32_bf16 v[104:107], v[64:67], v[56:59], v[104:107]
    ds_read_b64_tr_b16 v[64:65], v32 offset:8
    ds_read_b64_tr_b16 v[66:67], v32 offset:3848
    v_mfma_f32_16x16x32_bf16 v[108:111], v[68:71], v[52:55], v[108:111]
    v_mfma_f32_16x16x32_bf16 v[112:115], v[68:71], v[56:59], v[112:115]
    ds_read_b64_tr_b16 v[68:69], v32 offset:80
    ds_read_b64_tr_b16 v[70:71], v32 offset:3920
    v_mfma_f32_16x16x32_bf16 v[116:119], v[72:75], v[52:55], v[116:119]
    v_mfma_f32_16x16x32_bf16 v[120:123], v[72:75], v[56:59], v[120:123]
    ds_read_b64_tr_b16 v[72:73], v32 offset:88
    ds_read_b64_tr_b16 v[74:75], v32 offset:3928
    v_mfma_f32_16x16x32_bf16 v[124:127], v[76:79], v[52:55], v[124:127]
    v_mfma_f32_16x16x32_bf16 v[128:131], v[76:79], v[56:59], v[128:131]
    ds_read_b64_tr_b16 v[76:77], v35 offset:32
    ds_read_b64_tr_b16 v[78:79], v35 offset:3872
    v_mfma_f32_16x16x32_bf16 v[132:135], v[80:83], v[52:55], v[132:135]
    v_mfma_f32_16x16x32_bf16 v[136:139], v[80:83], v[56:59], v[136:139]
    ds_read_b64_tr_b16 v[80:81], v32 offset:160
    ds_read_b64_tr_b16 v[82:83], v32 offset:4000
    v_mfma_f32_16x16x32_bf16 v[140:143], v[84:87], v[52:55], v[140:143]
    v_mfma_f32_16x16x32_bf16 v[144:147], v[84:87], v[56:59], v[144:147]
    ds_read_b64_tr_b16 v[84:85], v32 offset:168
    ds_read_b64_tr_b16 v[86:87], v32 offset:4008
    v_mfma_f32_16x16x32_bf16 v[148:151], v[88:91], v[52:55], v[148:151]
    v_mfma_f32_16x16x32_bf16 v[152:155], v[88:91], v[56:59], v[152:155]
    ds_read_b64_tr_b16 v[88:89], v35 offset:192
    ds_read_b64_tr_b16 v[90:91], v35 offset:4032
    s_waitcnt lgkmcnt(8)
    ds_read_b128 v[52:55], v28 offset:0
    ds_read_b128 v[56:59], v28 offset:2048
    v_mfma_f32_16x16x32_bf16 v[92:95], v[60:63], v[44:47], v[92:95]
    v_mfma_f32_16x16x32_bf16 v[96:99], v[60:63], v[48:51], v[96:99]
    ds_read_b64_tr_b16 v[60:61], v32 offset:15360
    ds_read_b64_tr_b16 v[62:63], v32 offset:19200
    v_mfma_f32_16x16x32_bf16 v[100:103], v[64:67], v[44:47], v[100:103]
    v_mfma_f32_16x16x32_bf16 v[104:107], v[64:67], v[48:51], v[104:107]
    ds_read_b64_tr_b16 v[64:65], v32 offset:15368
    ds_read_b64_tr_b16 v[66:67], v32 offset:19208
    v_mfma_f32_16x16x32_bf16 v[108:111], v[68:71], v[44:47], v[108:111]
    v_mfma_f32_16x16x32_bf16 v[112:115], v[68:71], v[48:51], v[112:115]
    ds_read_b64_tr_b16 v[68:69], v32 offset:15440
    ds_read_b64_tr_b16 v[70:71], v32 offset:19280
    v_mfma_f32_16x16x32_bf16 v[116:119], v[72:75], v[44:47], v[116:119]
    v_mfma_f32_16x16x32_bf16 v[120:123], v[72:75], v[48:51], v[120:123]
    ds_read_b64_tr_b16 v[72:73], v32 offset:15448
    ds_read_b64_tr_b16 v[74:75], v32 offset:19288
    s_waitcnt lgkmcnt(10)
    v_mfma_f32_16x16x32_bf16 v[124:127], v[76:79], v[44:47], v[124:127]
    v_mfma_f32_16x16x32_bf16 v[128:131], v[76:79], v[48:51], v[128:131]
    ds_read_b64_tr_b16 v[76:77], v35 offset:15392
    ds_read_b64_tr_b16 v[78:79], v35 offset:19232
    v_mfma_f32_16x16x32_bf16 v[132:135], v[80:83], v[44:47], v[132:135]
    v_mfma_f32_16x16x32_bf16 v[136:139], v[80:83], v[48:51], v[136:139]
    ds_read_b64_tr_b16 v[80:81], v32 offset:15520
    ds_read_b64_tr_b16 v[82:83], v32 offset:19360
    v_mfma_f32_16x16x32_bf16 v[140:143], v[84:87], v[44:47], v[140:143]
    v_mfma_f32_16x16x32_bf16 v[144:147], v[84:87], v[48:51], v[144:147]
    ds_read_b64_tr_b16 v[84:85], v32 offset:15528
    ds_read_b64_tr_b16 v[86:87], v32 offset:19368
    v_mfma_f32_16x16x32_bf16 v[148:151], v[88:91], v[44:47], v[148:151]
    v_mfma_f32_16x16x32_bf16 v[152:155], v[88:91], v[48:51], v[152:155]
    ds_read_b64_tr_b16 v[88:89], v35 offset:15552
    ds_read_b64_tr_b16 v[90:91], v35 offset:19392
    s_waitcnt lgkmcnt(0)
    s_barrier
    ds_read_b128 v[44:47], v29 offset:0
    ds_read_b128 v[48:51], v29 offset:2048
    v_mfma_f32_16x16x32_bf16 v[92:95], v[60:63], v[52:55], v[92:95]
    v_mfma_f32_16x16x32_bf16 v[96:99], v[60:63], v[56:59], v[96:99]
    ds_read_b64_tr_b16 v[60:61], v33 offset:0
    ds_read_b64_tr_b16 v[62:63], v33 offset:3840
    v_mfma_f32_16x16x32_bf16 v[100:103], v[64:67], v[52:55], v[100:103]
    v_mfma_f32_16x16x32_bf16 v[104:107], v[64:67], v[56:59], v[104:107]
    ds_read_b64_tr_b16 v[64:65], v33 offset:8
    ds_read_b64_tr_b16 v[66:67], v33 offset:3848
    v_mfma_f32_16x16x32_bf16 v[108:111], v[68:71], v[52:55], v[108:111]
    v_mfma_f32_16x16x32_bf16 v[112:115], v[68:71], v[56:59], v[112:115]
    ds_read_b64_tr_b16 v[68:69], v33 offset:80
    ds_read_b64_tr_b16 v[70:71], v33 offset:3920
    v_mfma_f32_16x16x32_bf16 v[116:119], v[72:75], v[52:55], v[116:119]
    v_mfma_f32_16x16x32_bf16 v[120:123], v[72:75], v[56:59], v[120:123]
    ds_read_b64_tr_b16 v[72:73], v33 offset:88
    ds_read_b64_tr_b16 v[74:75], v33 offset:3928
    v_mfma_f32_16x16x32_bf16 v[124:127], v[76:79], v[52:55], v[124:127]
    v_mfma_f32_16x16x32_bf16 v[128:131], v[76:79], v[56:59], v[128:131]
    ds_read_b64_tr_b16 v[76:77], v36 offset:32
    ds_read_b64_tr_b16 v[78:79], v36 offset:3872
    v_mfma_f32_16x16x32_bf16 v[132:135], v[80:83], v[52:55], v[132:135]
    v_mfma_f32_16x16x32_bf16 v[136:139], v[80:83], v[56:59], v[136:139]
    ds_read_b64_tr_b16 v[80:81], v33 offset:160
    ds_read_b64_tr_b16 v[82:83], v33 offset:4000
    v_mfma_f32_16x16x32_bf16 v[140:143], v[84:87], v[52:55], v[140:143]
    v_mfma_f32_16x16x32_bf16 v[144:147], v[84:87], v[56:59], v[144:147]
    ds_read_b64_tr_b16 v[84:85], v33 offset:168
    ds_read_b64_tr_b16 v[86:87], v33 offset:4008
    v_mfma_f32_16x16x32_bf16 v[148:151], v[88:91], v[52:55], v[148:151]
    v_mfma_f32_16x16x32_bf16 v[152:155], v[88:91], v[56:59], v[152:155]
    ds_read_b64_tr_b16 v[88:89], v36 offset:192
    ds_read_b64_tr_b16 v[90:91], v36 offset:4032
    s_waitcnt lgkmcnt(8)
    ds_read_b128 v[52:55], v30 offset:0
    ds_read_b128 v[56:59], v30 offset:2048
    v_mfma_f32_16x16x32_bf16 v[92:95], v[60:63], v[44:47], v[92:95]
    v_mfma_f32_16x16x32_bf16 v[96:99], v[60:63], v[48:51], v[96:99]
    ds_read_b64_tr_b16 v[60:61], v33 offset:15360
    ds_read_b64_tr_b16 v[62:63], v33 offset:19200
    v_mfma_f32_16x16x32_bf16 v[100:103], v[64:67], v[44:47], v[100:103]
    v_mfma_f32_16x16x32_bf16 v[104:107], v[64:67], v[48:51], v[104:107]
    ds_read_b64_tr_b16 v[64:65], v33 offset:15368
    ds_read_b64_tr_b16 v[66:67], v33 offset:19208
    v_mfma_f32_16x16x32_bf16 v[108:111], v[68:71], v[44:47], v[108:111]
    v_mfma_f32_16x16x32_bf16 v[112:115], v[68:71], v[48:51], v[112:115]
    ds_read_b64_tr_b16 v[68:69], v33 offset:15440
    ds_read_b64_tr_b16 v[70:71], v33 offset:19280
    v_mfma_f32_16x16x32_bf16 v[116:119], v[72:75], v[44:47], v[116:119]
    v_mfma_f32_16x16x32_bf16 v[120:123], v[72:75], v[48:51], v[120:123]
    ds_read_b64_tr_b16 v[72:73], v33 offset:15448
    ds_read_b64_tr_b16 v[74:75], v33 offset:19288
    s_waitcnt lgkmcnt(10)
    v_mfma_f32_16x16x32_bf16 v[124:127], v[76:79], v[44:47], v[124:127]
    v_mfma_f32_16x16x32_bf16 v[128:131], v[76:79], v[48:51], v[128:131]
    ds_read_b64_tr_b16 v[76:77], v36 offset:15392
    ds_read_b64_tr_b16 v[78:79], v36 offset:19232
    v_mfma_f32_16x16x32_bf16 v[132:135], v[80:83], v[44:47], v[132:135]
    v_mfma_f32_16x16x32_bf16 v[136:139], v[80:83], v[48:51], v[136:139]
    ds_read_b64_tr_b16 v[80:81], v33 offset:15520
    ds_read_b64_tr_b16 v[82:83], v33 offset:19360
    v_mfma_f32_16x16x32_bf16 v[140:143], v[84:87], v[44:47], v[140:143]
    v_mfma_f32_16x16x32_bf16 v[144:147], v[84:87], v[48:51], v[144:147]
    ds_read_b64_tr_b16 v[84:85], v33 offset:15528
    ds_read_b64_tr_b16 v[86:87], v33 offset:19368
    v_mfma_f32_16x16x32_bf16 v[148:151], v[88:91], v[44:47], v[148:151]
    v_mfma_f32_16x16x32_bf16 v[152:155], v[88:91], v[48:51], v[152:155]
    ds_read_b64_tr_b16 v[88:89], v36 offset:15552
    ds_read_b64_tr_b16 v[90:91], v36 offset:19392
    s_waitcnt lgkmcnt(0)
    s_barrier
    ds_read_b128 v[44:47], v25 offset:0
    ds_read_b128 v[48:51], v25 offset:2048
    v_mfma_f32_16x16x32_bf16 v[92:95], v[60:63], v[52:55], v[92:95]
    v_mfma_f32_16x16x32_bf16 v[96:99], v[60:63], v[56:59], v[96:99]
    ds_read_b64_tr_b16 v[60:61], v31 offset:0
    ds_read_b64_tr_b16 v[62:63], v31 offset:3840
    v_mfma_f32_16x16x32_bf16 v[100:103], v[64:67], v[52:55], v[100:103]
    v_mfma_f32_16x16x32_bf16 v[104:107], v[64:67], v[56:59], v[104:107]
    ds_read_b64_tr_b16 v[64:65], v31 offset:8
    ds_read_b64_tr_b16 v[66:67], v31 offset:3848
    v_mfma_f32_16x16x32_bf16 v[108:111], v[68:71], v[52:55], v[108:111]
    v_mfma_f32_16x16x32_bf16 v[112:115], v[68:71], v[56:59], v[112:115]
    ds_read_b64_tr_b16 v[68:69], v31 offset:80
    ds_read_b64_tr_b16 v[70:71], v31 offset:3920
    v_mfma_f32_16x16x32_bf16 v[116:119], v[72:75], v[52:55], v[116:119]
    v_mfma_f32_16x16x32_bf16 v[120:123], v[72:75], v[56:59], v[120:123]
    ds_read_b64_tr_b16 v[72:73], v31 offset:88
    ds_read_b64_tr_b16 v[74:75], v31 offset:3928
    v_mfma_f32_16x16x32_bf16 v[124:127], v[76:79], v[52:55], v[124:127]
    v_mfma_f32_16x16x32_bf16 v[128:131], v[76:79], v[56:59], v[128:131]
    ds_read_b64_tr_b16 v[76:77], v34 offset:32
    ds_read_b64_tr_b16 v[78:79], v34 offset:3872
    v_mfma_f32_16x16x32_bf16 v[132:135], v[80:83], v[52:55], v[132:135]
    v_mfma_f32_16x16x32_bf16 v[136:139], v[80:83], v[56:59], v[136:139]
    ds_read_b64_tr_b16 v[80:81], v31 offset:160
    ds_read_b64_tr_b16 v[82:83], v31 offset:4000
    v_mfma_f32_16x16x32_bf16 v[140:143], v[84:87], v[52:55], v[140:143]
    v_mfma_f32_16x16x32_bf16 v[144:147], v[84:87], v[56:59], v[144:147]
    ds_read_b64_tr_b16 v[84:85], v31 offset:168
    ds_read_b64_tr_b16 v[86:87], v31 offset:4008
    v_mfma_f32_16x16x32_bf16 v[148:151], v[88:91], v[52:55], v[148:151]
    v_mfma_f32_16x16x32_bf16 v[152:155], v[88:91], v[56:59], v[152:155]
    ds_read_b64_tr_b16 v[88:89], v34 offset:192
    ds_read_b64_tr_b16 v[90:91], v34 offset:4032
    s_waitcnt lgkmcnt(8)
    ds_read_b128 v[52:55], v26 offset:0
    ds_read_b128 v[56:59], v26 offset:2048
    v_mfma_f32_16x16x32_bf16 v[92:95], v[60:63], v[44:47], v[92:95]
    v_mfma_f32_16x16x32_bf16 v[96:99], v[60:63], v[48:51], v[96:99]
    ds_read_b64_tr_b16 v[60:61], v31 offset:15360
    ds_read_b64_tr_b16 v[62:63], v31 offset:19200
    v_mfma_f32_16x16x32_bf16 v[100:103], v[64:67], v[44:47], v[100:103]
    v_mfma_f32_16x16x32_bf16 v[104:107], v[64:67], v[48:51], v[104:107]
    ds_read_b64_tr_b16 v[64:65], v31 offset:15368
    ds_read_b64_tr_b16 v[66:67], v31 offset:19208
    v_mfma_f32_16x16x32_bf16 v[108:111], v[68:71], v[44:47], v[108:111]
    v_mfma_f32_16x16x32_bf16 v[112:115], v[68:71], v[48:51], v[112:115]
    ds_read_b64_tr_b16 v[68:69], v31 offset:15440
    ds_read_b64_tr_b16 v[70:71], v31 offset:19280
    v_mfma_f32_16x16x32_bf16 v[116:119], v[72:75], v[44:47], v[116:119]
    v_mfma_f32_16x16x32_bf16 v[120:123], v[72:75], v[48:51], v[120:123]
    ds_read_b64_tr_b16 v[72:73], v31 offset:15448
    ds_read_b64_tr_b16 v[74:75], v31 offset:19288
    s_waitcnt lgkmcnt(10)
    v_mfma_f32_16x16x32_bf16 v[124:127], v[76:79], v[44:47], v[124:127]
    v_mfma_f32_16x16x32_bf16 v[128:131], v[76:79], v[48:51], v[128:131]
    ds_read_b64_tr_b16 v[76:77], v34 offset:15392
    ds_read_b64_tr_b16 v[78:79], v34 offset:19232
    v_mfma_f32_16x16x32_bf16 v[132:135], v[80:83], v[44:47], v[132:135]
    v_mfma_f32_16x16x32_bf16 v[136:139], v[80:83], v[48:51], v[136:139]
    ds_read_b64_tr_b16 v[80:81], v31 offset:15520
    ds_read_b64_tr_b16 v[82:83], v31 offset:19360
    v_mfma_f32_16x16x32_bf16 v[140:143], v[84:87], v[44:47], v[140:143]
    v_mfma_f32_16x16x32_bf16 v[144:147], v[84:87], v[48:51], v[144:147]
    ds_read_b64_tr_b16 v[84:85], v31 offset:15528
    ds_read_b64_tr_b16 v[86:87], v31 offset:19368
    v_mfma_f32_16x16x32_bf16 v[148:151], v[88:91], v[44:47], v[148:151]
    v_mfma_f32_16x16x32_bf16 v[152:155], v[88:91], v[48:51], v[152:155]
    ds_read_b64_tr_b16 v[88:89], v34 offset:15552
    ds_read_b64_tr_b16 v[90:91], v34 offset:19392
    s_waitcnt lgkmcnt(0)
    s_barrier
    ds_read_b128 v[44:47], v27 offset:0
    ds_read_b128 v[48:51], v27 offset:2048
    v_mfma_f32_16x16x32_bf16 v[92:95], v[60:63], v[52:55], v[92:95]
    v_mfma_f32_16x16x32_bf16 v[96:99], v[60:63], v[56:59], v[96:99]
    ds_read_b64_tr_b16 v[60:61], v32 offset:0
    ds_read_b64_tr_b16 v[62:63], v32 offset:3840
    v_mfma_f32_16x16x32_bf16 v[100:103], v[64:67], v[52:55], v[100:103]
    v_mfma_f32_16x16x32_bf16 v[104:107], v[64:67], v[56:59], v[104:107]
    ds_read_b64_tr_b16 v[64:65], v32 offset:8
    ds_read_b64_tr_b16 v[66:67], v32 offset:3848
    v_mfma_f32_16x16x32_bf16 v[108:111], v[68:71], v[52:55], v[108:111]
    v_mfma_f32_16x16x32_bf16 v[112:115], v[68:71], v[56:59], v[112:115]
    ds_read_b64_tr_b16 v[68:69], v32 offset:80
    ds_read_b64_tr_b16 v[70:71], v32 offset:3920
    v_mfma_f32_16x16x32_bf16 v[116:119], v[72:75], v[52:55], v[116:119]
    v_mfma_f32_16x16x32_bf16 v[120:123], v[72:75], v[56:59], v[120:123]
    ds_read_b64_tr_b16 v[72:73], v32 offset:88
    ds_read_b64_tr_b16 v[74:75], v32 offset:3928
    v_mfma_f32_16x16x32_bf16 v[124:127], v[76:79], v[52:55], v[124:127]
    v_mfma_f32_16x16x32_bf16 v[128:131], v[76:79], v[56:59], v[128:131]
    ds_read_b64_tr_b16 v[76:77], v35 offset:32
    ds_read_b64_tr_b16 v[78:79], v35 offset:3872
    v_mfma_f32_16x16x32_bf16 v[132:135], v[80:83], v[52:55], v[132:135]
    v_mfma_f32_16x16x32_bf16 v[136:139], v[80:83], v[56:59], v[136:139]
    ds_read_b64_tr_b16 v[80:81], v32 offset:160
    ds_read_b64_tr_b16 v[82:83], v32 offset:4000
    v_mfma_f32_16x16x32_bf16 v[140:143], v[84:87], v[52:55], v[140:143]
    v_mfma_f32_16x16x32_bf16 v[144:147], v[84:87], v[56:59], v[144:147]
    ds_read_b64_tr_b16 v[84:85], v32 offset:168
    ds_read_b64_tr_b16 v[86:87], v32 offset:4008
    v_mfma_f32_16x16x32_bf16 v[148:151], v[88:91], v[52:55], v[148:151]
    v_mfma_f32_16x16x32_bf16 v[152:155], v[88:91], v[56:59], v[152:155]
    ds_read_b64_tr_b16 v[88:89], v35 offset:192
    ds_read_b64_tr_b16 v[90:91], v35 offset:4032
    s_waitcnt lgkmcnt(8)
    ds_read_b128 v[52:55], v28 offset:0
    ds_read_b128 v[56:59], v28 offset:2048
    v_mfma_f32_16x16x32_bf16 v[92:95], v[60:63], v[44:47], v[92:95]
    v_mfma_f32_16x16x32_bf16 v[96:99], v[60:63], v[48:51], v[96:99]
    ds_read_b64_tr_b16 v[60:61], v32 offset:15360
    ds_read_b64_tr_b16 v[62:63], v32 offset:19200
    v_mfma_f32_16x16x32_bf16 v[100:103], v[64:67], v[44:47], v[100:103]
    v_mfma_f32_16x16x32_bf16 v[104:107], v[64:67], v[48:51], v[104:107]
    ds_read_b64_tr_b16 v[64:65], v32 offset:15368
    ds_read_b64_tr_b16 v[66:67], v32 offset:19208
    v_mfma_f32_16x16x32_bf16 v[108:111], v[68:71], v[44:47], v[108:111]
    v_mfma_f32_16x16x32_bf16 v[112:115], v[68:71], v[48:51], v[112:115]
    ds_read_b64_tr_b16 v[68:69], v32 offset:15440
    ds_read_b64_tr_b16 v[70:71], v32 offset:19280
    v_mfma_f32_16x16x32_bf16 v[116:119], v[72:75], v[44:47], v[116:119]
    v_mfma_f32_16x16x32_bf16 v[120:123], v[72:75], v[48:51], v[120:123]
    ds_read_b64_tr_b16 v[72:73], v32 offset:15448
    ds_read_b64_tr_b16 v[74:75], v32 offset:19288
    s_waitcnt lgkmcnt(10)
    v_mfma_f32_16x16x32_bf16 v[124:127], v[76:79], v[44:47], v[124:127]
    v_mfma_f32_16x16x32_bf16 v[128:131], v[76:79], v[48:51], v[128:131]
    ds_read_b64_tr_b16 v[76:77], v35 offset:15392
    ds_read_b64_tr_b16 v[78:79], v35 offset:19232
    v_mfma_f32_16x16x32_bf16 v[132:135], v[80:83], v[44:47], v[132:135]
    v_mfma_f32_16x16x32_bf16 v[136:139], v[80:83], v[48:51], v[136:139]
    ds_read_b64_tr_b16 v[80:81], v32 offset:15520
    ds_read_b64_tr_b16 v[82:83], v32 offset:19360
    v_mfma_f32_16x16x32_bf16 v[140:143], v[84:87], v[44:47], v[140:143]
    v_mfma_f32_16x16x32_bf16 v[144:147], v[84:87], v[48:51], v[144:147]
    ds_read_b64_tr_b16 v[84:85], v32 offset:15528
    ds_read_b64_tr_b16 v[86:87], v32 offset:19368
    v_mfma_f32_16x16x32_bf16 v[148:151], v[88:91], v[44:47], v[148:151]
    v_mfma_f32_16x16x32_bf16 v[152:155], v[88:91], v[48:51], v[152:155]
    ds_read_b64_tr_b16 v[88:89], v35 offset:15552
    ds_read_b64_tr_b16 v[90:91], v35 offset:19392
    s_waitcnt lgkmcnt(0)
    s_barrier
    ds_read_b128 v[44:47], v29 offset:0
    ds_read_b128 v[48:51], v29 offset:2048
    v_mfma_f32_16x16x32_bf16 v[92:95], v[60:63], v[52:55], v[92:95]
    v_mfma_f32_16x16x32_bf16 v[96:99], v[60:63], v[56:59], v[96:99]
    ds_read_b64_tr_b16 v[60:61], v33 offset:0
    ds_read_b64_tr_b16 v[62:63], v33 offset:3840
    v_mfma_f32_16x16x32_bf16 v[100:103], v[64:67], v[52:55], v[100:103]
    v_mfma_f32_16x16x32_bf16 v[104:107], v[64:67], v[56:59], v[104:107]
    ds_read_b64_tr_b16 v[64:65], v33 offset:8
    ds_read_b64_tr_b16 v[66:67], v33 offset:3848
    v_mfma_f32_16x16x32_bf16 v[108:111], v[68:71], v[52:55], v[108:111]
    v_mfma_f32_16x16x32_bf16 v[112:115], v[68:71], v[56:59], v[112:115]
    ds_read_b64_tr_b16 v[68:69], v33 offset:80
    ds_read_b64_tr_b16 v[70:71], v33 offset:3920
    v_mfma_f32_16x16x32_bf16 v[116:119], v[72:75], v[52:55], v[116:119]
    v_mfma_f32_16x16x32_bf16 v[120:123], v[72:75], v[56:59], v[120:123]
    ds_read_b64_tr_b16 v[72:73], v33 offset:88
    ds_read_b64_tr_b16 v[74:75], v33 offset:3928
    v_mfma_f32_16x16x32_bf16 v[124:127], v[76:79], v[52:55], v[124:127]
    v_mfma_f32_16x16x32_bf16 v[128:131], v[76:79], v[56:59], v[128:131]
    ds_read_b64_tr_b16 v[76:77], v36 offset:32
    ds_read_b64_tr_b16 v[78:79], v36 offset:3872
    v_mfma_f32_16x16x32_bf16 v[132:135], v[80:83], v[52:55], v[132:135]
    v_mfma_f32_16x16x32_bf16 v[136:139], v[80:83], v[56:59], v[136:139]
    ds_read_b64_tr_b16 v[80:81], v33 offset:160
    ds_read_b64_tr_b16 v[82:83], v33 offset:4000
    v_mfma_f32_16x16x32_bf16 v[140:143], v[84:87], v[52:55], v[140:143]
    v_mfma_f32_16x16x32_bf16 v[144:147], v[84:87], v[56:59], v[144:147]
    ds_read_b64_tr_b16 v[84:85], v33 offset:168
    ds_read_b64_tr_b16 v[86:87], v33 offset:4008
    v_mfma_f32_16x16x32_bf16 v[148:151], v[88:91], v[52:55], v[148:151]
    v_mfma_f32_16x16x32_bf16 v[152:155], v[88:91], v[56:59], v[152:155]
    ds_read_b64_tr_b16 v[88:89], v36 offset:192
    ds_read_b64_tr_b16 v[90:91], v36 offset:4032
    s_waitcnt lgkmcnt(8)
    ds_read_b128 v[52:55], v30 offset:0
    ds_read_b128 v[56:59], v30 offset:2048
    v_mfma_f32_16x16x32_bf16 v[92:95], v[60:63], v[44:47], v[92:95]
    v_mfma_f32_16x16x32_bf16 v[96:99], v[60:63], v[48:51], v[96:99]
    ds_read_b64_tr_b16 v[60:61], v33 offset:15360
    ds_read_b64_tr_b16 v[62:63], v33 offset:19200
    v_mfma_f32_16x16x32_bf16 v[100:103], v[64:67], v[44:47], v[100:103]
    v_mfma_f32_16x16x32_bf16 v[104:107], v[64:67], v[48:51], v[104:107]
    ds_read_b64_tr_b16 v[64:65], v33 offset:15368
    ds_read_b64_tr_b16 v[66:67], v33 offset:19208
    v_mfma_f32_16x16x32_bf16 v[108:111], v[68:71], v[44:47], v[108:111]
    v_mfma_f32_16x16x32_bf16 v[112:115], v[68:71], v[48:51], v[112:115]
    ds_read_b64_tr_b16 v[68:69], v33 offset:15440
    ds_read_b64_tr_b16 v[70:71], v33 offset:19280
    v_mfma_f32_16x16x32_bf16 v[116:119], v[72:75], v[44:47], v[116:119]
    v_mfma_f32_16x16x32_bf16 v[120:123], v[72:75], v[48:51], v[120:123]
    ds_read_b64_tr_b16 v[72:73], v33 offset:15448
    ds_read_b64_tr_b16 v[74:75], v33 offset:19288
    s_waitcnt lgkmcnt(10)
    v_mfma_f32_16x16x32_bf16 v[124:127], v[76:79], v[44:47], v[124:127]
    v_mfma_f32_16x16x32_bf16 v[128:131], v[76:79], v[48:51], v[128:131]
    ds_read_b64_tr_b16 v[76:77], v36 offset:15392
    ds_read_b64_tr_b16 v[78:79], v36 offset:19232
    v_mfma_f32_16x16x32_bf16 v[132:135], v[80:83], v[44:47], v[132:135]
    v_mfma_f32_16x16x32_bf16 v[136:139], v[80:83], v[48:51], v[136:139]
    ds_read_b64_tr_b16 v[80:81], v33 offset:15520
    ds_read_b64_tr_b16 v[82:83], v33 offset:19360
    v_mfma_f32_16x16x32_bf16 v[140:143], v[84:87], v[44:47], v[140:143]
    v_mfma_f32_16x16x32_bf16 v[144:147], v[84:87], v[48:51], v[144:147]
    ds_read_b64_tr_b16 v[84:85], v33 offset:15528
    ds_read_b64_tr_b16 v[86:87], v33 offset:19368
    v_mfma_f32_16x16x32_bf16 v[148:151], v[88:91], v[44:47], v[148:151]
    v_mfma_f32_16x16x32_bf16 v[152:155], v[88:91], v[48:51], v[152:155]
    ds_read_b64_tr_b16 v[88:89], v36 offset:15552
    ds_read_b64_tr_b16 v[90:91], v36 offset:19392
    s_waitcnt lgkmcnt(0)
    s_barrier
    ds_read_b128 v[44:47], v25 offset:0
    ds_read_b128 v[48:51], v25 offset:2048
    v_mfma_f32_16x16x32_bf16 v[92:95], v[60:63], v[52:55], v[92:95]
    v_mfma_f32_16x16x32_bf16 v[96:99], v[60:63], v[56:59], v[96:99]
    ds_read_b64_tr_b16 v[60:61], v31 offset:0
    ds_read_b64_tr_b16 v[62:63], v31 offset:3840
    v_mfma_f32_16x16x32_bf16 v[100:103], v[64:67], v[52:55], v[100:103]
    v_mfma_f32_16x16x32_bf16 v[104:107], v[64:67], v[56:59], v[104:107]
    ds_read_b64_tr_b16 v[64:65], v31 offset:8
    ds_read_b64_tr_b16 v[66:67], v31 offset:3848
    v_mfma_f32_16x16x32_bf16 v[108:111], v[68:71], v[52:55], v[108:111]
    v_mfma_f32_16x16x32_bf16 v[112:115], v[68:71], v[56:59], v[112:115]
    ds_read_b64_tr_b16 v[68:69], v31 offset:80
    ds_read_b64_tr_b16 v[70:71], v31 offset:3920
    v_mfma_f32_16x16x32_bf16 v[116:119], v[72:75], v[52:55], v[116:119]
    v_mfma_f32_16x16x32_bf16 v[120:123], v[72:75], v[56:59], v[120:123]
    ds_read_b64_tr_b16 v[72:73], v31 offset:88
    ds_read_b64_tr_b16 v[74:75], v31 offset:3928
    v_mfma_f32_16x16x32_bf16 v[124:127], v[76:79], v[52:55], v[124:127]
    v_mfma_f32_16x16x32_bf16 v[128:131], v[76:79], v[56:59], v[128:131]
    ds_read_b64_tr_b16 v[76:77], v34 offset:32
    ds_read_b64_tr_b16 v[78:79], v34 offset:3872
    v_mfma_f32_16x16x32_bf16 v[132:135], v[80:83], v[52:55], v[132:135]
    v_mfma_f32_16x16x32_bf16 v[136:139], v[80:83], v[56:59], v[136:139]
    ds_read_b64_tr_b16 v[80:81], v31 offset:160
    ds_read_b64_tr_b16 v[82:83], v31 offset:4000
    v_mfma_f32_16x16x32_bf16 v[140:143], v[84:87], v[52:55], v[140:143]
    v_mfma_f32_16x16x32_bf16 v[144:147], v[84:87], v[56:59], v[144:147]
    ds_read_b64_tr_b16 v[84:85], v31 offset:168
    ds_read_b64_tr_b16 v[86:87], v31 offset:4008
    v_mfma_f32_16x16x32_bf16 v[148:151], v[88:91], v[52:55], v[148:151]
    v_mfma_f32_16x16x32_bf16 v[152:155], v[88:91], v[56:59], v[152:155]
    ds_read_b64_tr_b16 v[88:89], v34 offset:192
    ds_read_b64_tr_b16 v[90:91], v34 offset:4032
    s_barrier
    s_waitcnt lgkmcnt(8)
    ds_read_b128 v[52:55], v26 offset:0
    ds_read_b128 v[56:59], v26 offset:2048
    v_mfma_f32_16x16x32_bf16 v[92:95], v[60:63], v[44:47], v[92:95]
    v_mfma_f32_16x16x32_bf16 v[96:99], v[60:63], v[48:51], v[96:99]
    ds_read_b64_tr_b16 v[60:61], v31 offset:15360
    ds_read_b64_tr_b16 v[62:63], v31 offset:19200
    v_mfma_f32_16x16x32_bf16 v[100:103], v[64:67], v[44:47], v[100:103]
    v_mfma_f32_16x16x32_bf16 v[104:107], v[64:67], v[48:51], v[104:107]
    ds_read_b64_tr_b16 v[64:65], v31 offset:15368
    ds_read_b64_tr_b16 v[66:67], v31 offset:19208
    v_mfma_f32_16x16x32_bf16 v[108:111], v[68:71], v[44:47], v[108:111]
    v_mfma_f32_16x16x32_bf16 v[112:115], v[68:71], v[48:51], v[112:115]
    ds_read_b64_tr_b16 v[68:69], v31 offset:15440
    ds_read_b64_tr_b16 v[70:71], v31 offset:19280
    v_mfma_f32_16x16x32_bf16 v[116:119], v[72:75], v[44:47], v[116:119]
    v_mfma_f32_16x16x32_bf16 v[120:123], v[72:75], v[48:51], v[120:123]
    ds_read_b64_tr_b16 v[72:73], v31 offset:15448
    ds_read_b64_tr_b16 v[74:75], v31 offset:19288
    s_waitcnt lgkmcnt(10)
    v_mfma_f32_16x16x32_bf16 v[124:127], v[76:79], v[44:47], v[124:127]
    v_mfma_f32_16x16x32_bf16 v[128:131], v[76:79], v[48:51], v[128:131]
    ds_read_b64_tr_b16 v[76:77], v34 offset:15392
    ds_read_b64_tr_b16 v[78:79], v34 offset:19232
    v_mfma_f32_16x16x32_bf16 v[132:135], v[80:83], v[44:47], v[132:135]
    v_mfma_f32_16x16x32_bf16 v[136:139], v[80:83], v[48:51], v[136:139]
    ds_read_b64_tr_b16 v[80:81], v31 offset:15520
    ds_read_b64_tr_b16 v[82:83], v31 offset:19360
    v_mfma_f32_16x16x32_bf16 v[140:143], v[84:87], v[44:47], v[140:143]
    v_mfma_f32_16x16x32_bf16 v[144:147], v[84:87], v[48:51], v[144:147]
    ds_read_b64_tr_b16 v[84:85], v31 offset:15528
    ds_read_b64_tr_b16 v[86:87], v31 offset:19368
    v_mfma_f32_16x16x32_bf16 v[148:151], v[88:91], v[44:47], v[148:151]
    v_mfma_f32_16x16x32_bf16 v[152:155], v[88:91], v[48:51], v[152:155]
    ds_read_b64_tr_b16 v[88:89], v34 offset:15552
    ds_read_b64_tr_b16 v[90:91], v34 offset:19392
    s_waitcnt lgkmcnt(0)
    s_barrier
    v_mfma_f32_16x16x32_bf16 v[92:95], v[60:63], v[52:55], v[92:95]
    v_mfma_f32_16x16x32_bf16 v[96:99], v[60:63], v[56:59], v[96:99]
    v_mfma_f32_16x16x32_bf16 v[100:103], v[64:67], v[52:55], v[100:103]
    v_mfma_f32_16x16x32_bf16 v[104:107], v[64:67], v[56:59], v[104:107]
    v_mfma_f32_16x16x32_bf16 v[108:111], v[68:71], v[52:55], v[108:111]
    v_mfma_f32_16x16x32_bf16 v[112:115], v[68:71], v[56:59], v[112:115]
    v_mfma_f32_16x16x32_bf16 v[116:119], v[72:75], v[52:55], v[116:119]
    v_mfma_f32_16x16x32_bf16 v[120:123], v[72:75], v[56:59], v[120:123]
    v_mfma_f32_16x16x32_bf16 v[124:127], v[76:79], v[52:55], v[124:127]
    v_mfma_f32_16x16x32_bf16 v[128:131], v[76:79], v[56:59], v[128:131]
    v_mfma_f32_16x16x32_bf16 v[132:135], v[80:83], v[52:55], v[132:135]
    v_mfma_f32_16x16x32_bf16 v[136:139], v[80:83], v[56:59], v[136:139]
    v_mfma_f32_16x16x32_bf16 v[140:143], v[84:87], v[52:55], v[140:143]
    v_mfma_f32_16x16x32_bf16 v[144:147], v[84:87], v[56:59], v[144:147]
    v_mfma_f32_16x16x32_bf16 v[148:151], v[88:91], v[52:55], v[148:151]
    v_mfma_f32_16x16x32_bf16 v[152:155], v[88:91], v[56:59], v[152:155]
    s_nop 2
    v_cvt_pk_bf16_f32 v132, v132, v133
    v_cvt_pk_bf16_f32 v133, v134, v135
    v_cvt_pk_bf16_f32 v134, v140, v141
    v_cvt_pk_bf16_f32 v135, v142, v143
    ds_write_b128 v37, v[132:135] offset:0
    v_cvt_pk_bf16_f32 v136, v136, v137
    v_cvt_pk_bf16_f32 v137, v138, v139
    v_cvt_pk_bf16_f32 v138, v144, v145
    v_cvt_pk_bf16_f32 v139, v146, v147
    ds_write_b128 v37, v[136:139] offset:64
    v_cvt_pk_bf16_f32 v148, v148, v149
    v_cvt_pk_bf16_f32 v149, v150, v151
    ds_write_b64 v38, v[148:149] offset:0
    v_cvt_pk_bf16_f32 v152, v152, v153
    v_cvt_pk_bf16_f32 v153, v154, v155
    ds_write_b64 v38, v[152:153] offset:32
    s_waitcnt lgkmcnt(0)
    s_barrier
    v_pk_mul_f32 v[92:93], v[92:93], s[58:59]
    v_pk_mul_f32 v[94:95], v[94:95], s[58:59]
    v_pk_mul_f32 v[100:101], v[100:101], s[58:59]
    v_pk_mul_f32 v[102:103], v[102:103], s[58:59]
    v_cvt_pk_bf16_f32 v92, v92, v93
    v_cvt_pk_bf16_f32 v93, v94, v95
    v_cvt_pk_bf16_f32 v94, v100, v101
    v_cvt_pk_bf16_f32 v95, v102, v103
    ds_write_b128 v39, v[92:95] offset:0
    v_pk_mul_f32 v[96:97], v[96:97], s[58:59]
    v_pk_mul_f32 v[98:99], v[98:99], s[58:59]
    v_pk_mul_f32 v[104:105], v[104:105], s[58:59]
    v_pk_mul_f32 v[106:107], v[106:107], s[58:59]
    v_cvt_pk_bf16_f32 v96, v96, v97
    v_cvt_pk_bf16_f32 v97, v98, v99
    v_cvt_pk_bf16_f32 v98, v104, v105
    v_cvt_pk_bf16_f32 v99, v106, v107
    ds_write_b128 v39, v[96:99] offset:256
    v_pk_mul_f32 v[108:109], v[108:109], s[58:59]
    v_pk_mul_f32 v[110:111], v[110:111], s[58:59]
    v_pk_mul_f32 v[116:117], v[116:117], s[58:59]
    v_pk_mul_f32 v[118:119], v[118:119], s[58:59]
    v_cvt_pk_bf16_f32 v108, v108, v109
    v_cvt_pk_bf16_f32 v109, v110, v111
    v_cvt_pk_bf16_f32 v110, v116, v117
    v_cvt_pk_bf16_f32 v111, v118, v119
    ds_write_b128 v39, v[108:111] offset:10240
    v_pk_mul_f32 v[112:113], v[112:113], s[58:59]
    v_pk_mul_f32 v[114:115], v[114:115], s[58:59]
    v_pk_mul_f32 v[120:121], v[120:121], s[58:59]
    v_pk_mul_f32 v[122:123], v[122:123], s[58:59]
    v_cvt_pk_bf16_f32 v112, v112, v113
    v_cvt_pk_bf16_f32 v113, v114, v115
    v_cvt_pk_bf16_f32 v114, v120, v121
    v_cvt_pk_bf16_f32 v115, v122, v123
    ds_write_b128 v39, v[112:115] offset:10496
    v_pk_mul_f32 v[124:125], v[124:125], s[58:59]
    v_pk_mul_f32 v[126:127], v[126:127], s[58:59]
    v_cvt_pk_bf16_f32 v124, v124, v125
    v_cvt_pk_bf16_f32 v125, v126, v127
    ds_write_b64 v40, v[124:125] offset:0
    v_pk_mul_f32 v[128:129], v[128:129], s[58:59]
    v_pk_mul_f32 v[130:131], v[130:131], s[58:59]
    v_cvt_pk_bf16_f32 v128, v128, v129
    v_cvt_pk_bf16_f32 v129, v130, v131
    ds_write_b64 v40, v[128:129] offset:128
    s_nop 1
    s_branch concat_heads__mha_block__mha_block__prompt_kernel_p2
concat_heads__mha_block__mha_block__prompt_kernel_p1b:
    s_add_u32 s36, s36, 1280
    v_mul_u32_u24 v4, 640, v4
    v_mul_u32_u24 v5, 320, v5
    v_add3_u32 v7, v4, v5, s36
    v_add_u32 v4, 0, v2
    v_mul_u32_u24 v5, 3277, v4
    v_lshrrev_b32 v5, 16, v5
    v_mul_u32_u24 v5, 9920, v5
    v_lshl_add_u32 v4, v4, 4, v5
    v_add_u32 v38, v4, v7
    v_add_u32 v4, 16, v2
    v_mul_u32_u24 v5, 3277, v4
    v_lshrrev_b32 v5, 16, v5
    v_mul_u32_u24 v5, 9920, v5
    v_lshl_add_u32 v4, v4, 4, v5
    v_add_u32 v39, v4, v7
    v_add_u32 v4, 32, v2
    v_mul_u32_u24 v5, 3277, v4
    v_lshrrev_b32 v5, 16, v5
    v_mul_u32_u24 v5, 9920, v5
    v_lshl_add_u32 v4, v4, 4, v5
    v_add_u32 v40, v4, v7
    v_add_u32 v4, 48, v2
    v_mul_u32_u24 v5, 3277, v4
    v_lshrrev_b32 v5, 16, v5
    v_mul_u32_u24 v5, 9920, v5
    v_lshl_add_u32 v4, v4, 4, v5
    v_add_u32 v41, v4, v7
    v_add_u32 v4, 64, v2
    v_mul_u32_u24 v5, 3277, v4
    v_lshrrev_b32 v5, 16, v5
    v_mul_u32_u24 v5, 9920, v5
    v_lshl_add_u32 v4, v4, 4, v5
    v_add_u32 v42, v4, v7
    s_waitcnt vmcnt(0) lgkmcnt(0)
    s_barrier
    s_add_u32 s61, s61, 2654435769
    ds_read_b128 v[44:47], v25 offset:0
    ds_read_b128 v[48:51], v25 offset:2048
    ds_read_b64_tr_b16 v[60:61], v31 offset:240
    ds_read_b64_tr_b16 v[62:63], v31 offset:4080
    ds_read_b64_tr_b16 v[64:65], v31 offset:248
    ds_read_b64_tr_b16 v[66:67], v31 offset:4088
    ds_read_b64_tr_b16 v[68:69], v34 offset:320
    ds_read_b64_tr_b16 v[70:71], v34 offset:4160
    ds_read_b64_tr_b16 v[72:73], v34 offset:352
    ds_read_b64_tr_b16 v[74:75], v34 offset:4192
    ds_read_b64_tr_b16 v[76:77], v34 offset:384
    ds_read_b64_tr_b16 v[78:79], v34 offset:4224
    ds_read_b64_tr_b16 v[80:81], v34 offset:416
    ds_read_b64_tr_b16 v[82:83], v34 offset:4256
    ds_read_b64_tr_b16 v[84:85], v34 offset:448
    ds_read_b64_tr_b16 v[86:87], v34 offset:4288
    s_waitcnt lgkmcnt(6)
    ds_read_b128 v[52:55], v26 offset:0
    ds_read_b128 v[56:59], v26 offset:2048
    v_mfma_f32_16x16x32_bf16 v[92:95], v[60:63], v[44:47], v[92:95]
    v_mfma_f32_16x16x32_bf16 v[96:99], v[60:63], v[48:51], v[96:99]
    ds_read_b64_tr_b16 v[60:61], v31 offset:15600
    ds_read_b64_tr_b16 v[62:63], v31 offset:19440
    v_mfma_f32_16x16x32_bf16 v[100:103], v[64:67], v[44:47], v[100:103]
    v_mfma_f32_16x16x32_bf16 v[104:107], v[64:67], v[48:51], v[104:107]
    ds_read_b64_tr_b16 v[64:65], v31 offset:15608
    ds_read_b64_tr_b16 v[66:67], v31 offset:19448
    v_mfma_f32_16x16x32_bf16 v[108:111], v[44:47], v[68:71], v[108:111]
    v_mfma_f32_16x16x32_bf16 v[112:115], v[48:51], v[68:71], v[112:115]
    ds_read_b64_tr_b16 v[68:69], v34 offset:15680
    ds_read_b64_tr_b16 v[70:71], v34 offset:19520
    v_mfma_f32_16x16x32_bf16 v[116:119], v[44:47], v[72:75], v[116:119]
    v_mfma_f32_16x16x32_bf16 v[120:123], v[48:51], v[72:75], v[120:123]
    ds_read_b64_tr_b16 v[72:73], v34 offset:15712
    ds_read_b64_tr_b16 v[74:75], v34 offset:19552
    s_waitcnt lgkmcnt(10)
    v_mfma_f32_16x16x32_bf16 v[124:127], v[44:47], v[76:79], v[124:127]
    v_mfma_f32_16x16x32_bf16 v[128:131], v[48:51], v[76:79], v[128:131]
    ds_read_b64_tr_b16 v[76:77], v34 offset:15744
    ds_read_b64_tr_b16 v[78:79], v34 offset:19584
    v_mfma_f32_16x16x32_bf16 v[132:135], v[44:47], v[80:83], v[132:135]
    v_mfma_f32_16x16x32_bf16 v[136:139], v[48:51], v[80:83], v[136:139]
    ds_read_b64_tr_b16 v[80:81], v34 offset:15776
    ds_read_b64_tr_b16 v[82:83], v34 offset:19616
    v_mfma_f32_16x16x32_bf16 v[140:143], v[44:47], v[84:87], v[140:143]
    v_mfma_f32_16x16x32_bf16 v[144:147], v[48:51], v[84:87], v[144:147]
    ds_read_b64_tr_b16 v[84:85], v34 offset:15808
    ds_read_b64_tr_b16 v[86:87], v34 offset:19648
    s_waitcnt lgkmcnt(0)
    s_barrier
    ds_read_b128 v[44:47], v27 offset:0
    ds_read_b128 v[48:51], v27 offset:2048
    v_mfma_f32_16x16x32_bf16 v[92:95], v[60:63], v[52:55], v[92:95]
    v_mfma_f32_16x16x32_bf16 v[96:99], v[60:63], v[56:59], v[96:99]
    ds_read_b64_tr_b16 v[60:61], v32 offset:240
    ds_read_b64_tr_b16 v[62:63], v32 offset:4080
    v_mfma_f32_16x16x32_bf16 v[100:103], v[64:67], v[52:55], v[100:103]
    v_mfma_f32_16x16x32_bf16 v[104:107], v[64:67], v[56:59], v[104:107]
    ds_read_b64_tr_b16 v[64:65], v32 offset:248
    ds_read_b64_tr_b16 v[66:67], v32 offset:4088
    v_mfma_f32_16x16x32_bf16 v[108:111], v[52:55], v[68:71], v[108:111]
    v_mfma_f32_16x16x32_bf16 v[112:115], v[56:59], v[68:71], v[112:115]
    ds_read_b64_tr_b16 v[68:69], v35 offset:320
    ds_read_b64_tr_b16 v[70:71], v35 offset:4160
    v_mfma_f32_16x16x32_bf16 v[116:119], v[52:55], v[72:75], v[116:119]
    v_mfma_f32_16x16x32_bf16 v[120:123], v[56:59], v[72:75], v[120:123]
    ds_read_b64_tr_b16 v[72:73], v35 offset:352
    ds_read_b64_tr_b16 v[74:75], v35 offset:4192
    v_mfma_f32_16x16x32_bf16 v[124:127], v[52:55], v[76:79], v[124:127]
    v_mfma_f32_16x16x32_bf16 v[128:131], v[56:59], v[76:79], v[128:131]
    ds_read_b64_tr_b16 v[76:77], v35 offset:384
    ds_read_b64_tr_b16 v[78:79], v35 offset:4224
    v_mfma_f32_16x16x32_bf16 v[132:135], v[52:55], v[80:83], v[132:135]
    v_mfma_f32_16x16x32_bf16 v[136:139], v[56:59], v[80:83], v[136:139]
    ds_read_b64_tr_b16 v[80:81], v35 offset:416
    ds_read_b64_tr_b16 v[82:83], v35 offset:4256
    v_mfma_f32_16x16x32_bf16 v[140:143], v[52:55], v[84:87], v[140:143]
    v_mfma_f32_16x16x32_bf16 v[144:147], v[56:59], v[84:87], v[144:147]
    ds_read_b64_tr_b16 v[84:85], v35 offset:448
    ds_read_b64_tr_b16 v[86:87], v35 offset:4288
    s_waitcnt lgkmcnt(6)
    ds_read_b128 v[52:55], v28 offset:0
    ds_read_b128 v[56:59], v28 offset:2048
    v_mfma_f32_16x16x32_bf16 v[92:95], v[60:63], v[44:47], v[92:95]
    v_mfma_f32_16x16x32_bf16 v[96:99], v[60:63], v[48:51], v[96:99]
    ds_read_b64_tr_b16 v[60:61], v32 offset:15600
    ds_read_b64_tr_b16 v[62:63], v32 offset:19440
    v_mfma_f32_16x16x32_bf16 v[100:103], v[64:67], v[44:47], v[100:103]
    v_mfma_f32_16x16x32_bf16 v[104:107], v[64:67], v[48:51], v[104:107]
    ds_read_b64_tr_b16 v[64:65], v32 offset:15608
    ds_read_b64_tr_b16 v[66:67], v32 offset:19448
    v_mfma_f32_16x16x32_bf16 v[108:111], v[44:47], v[68:71], v[108:111]
    v_mfma_f32_16x16x32_bf16 v[112:115], v[48:51], v[68:71], v[112:115]
    ds_read_b64_tr_b16 v[68:69], v35 offset:15680
    ds_read_b64_tr_b16 v[70:71], v35 offset:19520
    v_mfma_f32_16x16x32_bf16 v[116:119], v[44:47], v[72:75], v[116:119]
    v_mfma_f32_16x16x32_bf16 v[120:123], v[48:51], v[72:75], v[120:123]
    ds_read_b64_tr_b16 v[72:73], v35 offset:15712
    ds_read_b64_tr_b16 v[74:75], v35 offset:19552
    s_waitcnt lgkmcnt(10)
    v_mfma_f32_16x16x32_bf16 v[124:127], v[44:47], v[76:79], v[124:127]
    v_mfma_f32_16x16x32_bf16 v[128:131], v[48:51], v[76:79], v[128:131]
    ds_read_b64_tr_b16 v[76:77], v35 offset:15744
    ds_read_b64_tr_b16 v[78:79], v35 offset:19584
    v_mfma_f32_16x16x32_bf16 v[132:135], v[44:47], v[80:83], v[132:135]
    v_mfma_f32_16x16x32_bf16 v[136:139], v[48:51], v[80:83], v[136:139]
    ds_read_b64_tr_b16 v[80:81], v35 offset:15776
    ds_read_b64_tr_b16 v[82:83], v35 offset:19616
    v_mfma_f32_16x16x32_bf16 v[140:143], v[44:47], v[84:87], v[140:143]
    v_mfma_f32_16x16x32_bf16 v[144:147], v[48:51], v[84:87], v[144:147]
    ds_read_b64_tr_b16 v[84:85], v35 offset:15808
    ds_read_b64_tr_b16 v[86:87], v35 offset:19648
    s_waitcnt lgkmcnt(0)
    s_barrier
    ds_read_b128 v[44:47], v29 offset:0
    ds_read_b128 v[48:51], v29 offset:2048
    v_mfma_f32_16x16x32_bf16 v[92:95], v[60:63], v[52:55], v[92:95]
    v_mfma_f32_16x16x32_bf16 v[96:99], v[60:63], v[56:59], v[96:99]
    ds_read_b64_tr_b16 v[60:61], v33 offset:240
    ds_read_b64_tr_b16 v[62:63], v33 offset:4080
    v_mfma_f32_16x16x32_bf16 v[100:103], v[64:67], v[52:55], v[100:103]
    v_mfma_f32_16x16x32_bf16 v[104:107], v[64:67], v[56:59], v[104:107]
    ds_read_b64_tr_b16 v[64:65], v33 offset:248
    ds_read_b64_tr_b16 v[66:67], v33 offset:4088
    v_mfma_f32_16x16x32_bf16 v[108:111], v[52:55], v[68:71], v[108:111]
    v_mfma_f32_16x16x32_bf16 v[112:115], v[56:59], v[68:71], v[112:115]
    ds_read_b64_tr_b16 v[68:69], v36 offset:320
    ds_read_b64_tr_b16 v[70:71], v36 offset:4160
    v_mfma_f32_16x16x32_bf16 v[116:119], v[52:55], v[72:75], v[116:119]
    v_mfma_f32_16x16x32_bf16 v[120:123], v[56:59], v[72:75], v[120:123]
    ds_read_b64_tr_b16 v[72:73], v36 offset:352
    ds_read_b64_tr_b16 v[74:75], v36 offset:4192
    v_mfma_f32_16x16x32_bf16 v[124:127], v[52:55], v[76:79], v[124:127]
    v_mfma_f32_16x16x32_bf16 v[128:131], v[56:59], v[76:79], v[128:131]
    ds_read_b64_tr_b16 v[76:77], v36 offset:384
    ds_read_b64_tr_b16 v[78:79], v36 offset:4224
    v_mfma_f32_16x16x32_bf16 v[132:135], v[52:55], v[80:83], v[132:135]
    v_mfma_f32_16x16x32_bf16 v[136:139], v[56:59], v[80:83], v[136:139]
    ds_read_b64_tr_b16 v[80:81], v36 offset:416
    ds_read_b64_tr_b16 v[82:83], v36 offset:4256
    v_mfma_f32_16x16x32_bf16 v[140:143], v[52:55], v[84:87], v[140:143]
    v_mfma_f32_16x16x32_bf16 v[144:147], v[56:59], v[84:87], v[144:147]
    ds_read_b64_tr_b16 v[84:85], v36 offset:448
    ds_read_b64_tr_b16 v[86:87], v36 offset:4288
    s_waitcnt lgkmcnt(6)
    ds_read_b128 v[52:55], v30 offset:0
    ds_read_b128 v[56:59], v30 offset:2048
    v_mfma_f32_16x16x32_bf16 v[92:95], v[60:63], v[44:47], v[92:95]
    v_mfma_f32_16x16x32_bf16 v[96:99], v[60:63], v[48:51], v[96:99]
    ds_read_b64_tr_b16 v[60:61], v33 offset:15600
    ds_read_b64_tr_b16 v[62:63], v33 offset:19440
    v_mfma_f32_16x16x32_bf16 v[100:103], v[64:67], v[44:47], v[100:103]
    v_mfma_f32_16x16x32_bf16 v[104:107], v[64:67], v[48:51], v[104:107]
    ds_read_b64_tr_b16 v[64:65], v33 offset:15608
    ds_read_b64_tr_b16 v[66:67], v33 offset:19448
    v_mfma_f32_16x16x32_bf16 v[108:111], v[44:47], v[68:71], v[108:111]
    v_mfma_f32_16x16x32_bf16 v[112:115], v[48:51], v[68:71], v[112:115]
    ds_read_b64_tr_b16 v[68:69], v36 offset:15680
    ds_read_b64_tr_b16 v[70:71], v36 offset:19520
    v_mfma_f32_16x16x32_bf16 v[116:119], v[44:47], v[72:75], v[116:119]
    v_mfma_f32_16x16x32_bf16 v[120:123], v[48:51], v[72:75], v[120:123]
    ds_read_b64_tr_b16 v[72:73], v36 offset:15712
    ds_read_b64_tr_b16 v[74:75], v36 offset:19552
    s_waitcnt lgkmcnt(10)
    v_mfma_f32_16x16x32_bf16 v[124:127], v[44:47], v[76:79], v[124:127]
    v_mfma_f32_16x16x32_bf16 v[128:131], v[48:51], v[76:79], v[128:131]
    ds_read_b64_tr_b16 v[76:77], v36 offset:15744
    ds_read_b64_tr_b16 v[78:79], v36 offset:19584
    v_mfma_f32_16x16x32_bf16 v[132:135], v[44:47], v[80:83], v[132:135]
    v_mfma_f32_16x16x32_bf16 v[136:139], v[48:51], v[80:83], v[136:139]
    ds_read_b64_tr_b16 v[80:81], v36 offset:15776
    ds_read_b64_tr_b16 v[82:83], v36 offset:19616
    v_mfma_f32_16x16x32_bf16 v[140:143], v[44:47], v[84:87], v[140:143]
    v_mfma_f32_16x16x32_bf16 v[144:147], v[48:51], v[84:87], v[144:147]
    ds_read_b64_tr_b16 v[84:85], v36 offset:15808
    ds_read_b64_tr_b16 v[86:87], v36 offset:19648
    s_waitcnt lgkmcnt(0)
    s_barrier
    ds_read_b128 v[44:47], v25 offset:0
    ds_read_b128 v[48:51], v25 offset:2048
    v_mfma_f32_16x16x32_bf16 v[92:95], v[60:63], v[52:55], v[92:95]
    v_mfma_f32_16x16x32_bf16 v[96:99], v[60:63], v[56:59], v[96:99]
    ds_read_b64_tr_b16 v[60:61], v31 offset:240
    ds_read_b64_tr_b16 v[62:63], v31 offset:4080
    v_mfma_f32_16x16x32_bf16 v[100:103], v[64:67], v[52:55], v[100:103]
    v_mfma_f32_16x16x32_bf16 v[104:107], v[64:67], v[56:59], v[104:107]
    ds_read_b64_tr_b16 v[64:65], v31 offset:248
    ds_read_b64_tr_b16 v[66:67], v31 offset:4088
    v_mfma_f32_16x16x32_bf16 v[108:111], v[52:55], v[68:71], v[108:111]
    v_mfma_f32_16x16x32_bf16 v[112:115], v[56:59], v[68:71], v[112:115]
    ds_read_b64_tr_b16 v[68:69], v34 offset:320
    ds_read_b64_tr_b16 v[70:71], v34 offset:4160
    v_mfma_f32_16x16x32_bf16 v[116:119], v[52:55], v[72:75], v[116:119]
    v_mfma_f32_16x16x32_bf16 v[120:123], v[56:59], v[72:75], v[120:123]
    ds_read_b64_tr_b16 v[72:73], v34 offset:352
    ds_read_b64_tr_b16 v[74:75], v34 offset:4192
    v_mfma_f32_16x16x32_bf16 v[124:127], v[52:55], v[76:79], v[124:127]
    v_mfma_f32_16x16x32_bf16 v[128:131], v[56:59], v[76:79], v[128:131]
    ds_read_b64_tr_b16 v[76:77], v34 offset:384
    ds_read_b64_tr_b16 v[78:79], v34 offset:4224
    v_mfma_f32_16x16x32_bf16 v[132:135], v[52:55], v[80:83], v[132:135]
    v_mfma_f32_16x16x32_bf16 v[136:139], v[56:59], v[80:83], v[136:139]
    ds_read_b64_tr_b16 v[80:81], v34 offset:416
    ds_read_b64_tr_b16 v[82:83], v34 offset:4256
    v_mfma_f32_16x16x32_bf16 v[140:143], v[52:55], v[84:87], v[140:143]
    v_mfma_f32_16x16x32_bf16 v[144:147], v[56:59], v[84:87], v[144:147]
    ds_read_b64_tr_b16 v[84:85], v34 offset:448
    ds_read_b64_tr_b16 v[86:87], v34 offset:4288
    s_waitcnt lgkmcnt(6)
    ds_read_b128 v[52:55], v26 offset:0
    ds_read_b128 v[56:59], v26 offset:2048
    v_mfma_f32_16x16x32_bf16 v[92:95], v[60:63], v[44:47], v[92:95]
    v_mfma_f32_16x16x32_bf16 v[96:99], v[60:63], v[48:51], v[96:99]
    ds_read_b64_tr_b16 v[60:61], v31 offset:15600
    ds_read_b64_tr_b16 v[62:63], v31 offset:19440
    v_mfma_f32_16x16x32_bf16 v[100:103], v[64:67], v[44:47], v[100:103]
    v_mfma_f32_16x16x32_bf16 v[104:107], v[64:67], v[48:51], v[104:107]
    ds_read_b64_tr_b16 v[64:65], v31 offset:15608
    ds_read_b64_tr_b16 v[66:67], v31 offset:19448
    v_mfma_f32_16x16x32_bf16 v[108:111], v[44:47], v[68:71], v[108:111]
    v_mfma_f32_16x16x32_bf16 v[112:115], v[48:51], v[68:71], v[112:115]
    ds_read_b64_tr_b16 v[68:69], v34 offset:15680
    ds_read_b64_tr_b16 v[70:71], v34 offset:19520
    v_mfma_f32_16x16x32_bf16 v[116:119], v[44:47], v[72:75], v[116:119]
    v_mfma_f32_16x16x32_bf16 v[120:123], v[48:51], v[72:75], v[120:123]
    ds_read_b64_tr_b16 v[72:73], v34 offset:15712
    ds_read_b64_tr_b16 v[74:75], v34 offset:19552
    s_waitcnt lgkmcnt(10)
    v_mfma_f32_16x16x32_bf16 v[124:127], v[44:47], v[76:79], v[124:127]
    v_mfma_f32_16x16x32_bf16 v[128:131], v[48:51], v[76:79], v[128:131]
    ds_read_b64_tr_b16 v[76:77], v34 offset:15744
    ds_read_b64_tr_b16 v[78:79], v34 offset:19584
    v_mfma_f32_16x16x32_bf16 v[132:135], v[44:47], v[80:83], v[132:135]
    v_mfma_f32_16x16x32_bf16 v[136:139], v[48:51], v[80:83], v[136:139]
    ds_read_b64_tr_b16 v[80:81], v34 offset:15776
    ds_read_b64_tr_b16 v[82:83], v34 offset:19616
    v_mfma_f32_16x16x32_bf16 v[140:143], v[44:47], v[84:87], v[140:143]
    v_mfma_f32_16x16x32_bf16 v[144:147], v[48:51], v[84:87], v[144:147]
    ds_read_b64_tr_b16 v[84:85], v34 offset:15808
    ds_read_b64_tr_b16 v[86:87], v34 offset:19648
    s_waitcnt lgkmcnt(0)
    s_barrier
    ds_read_b128 v[44:47], v27 offset:0
    ds_read_b128 v[48:51], v27 offset:2048
    v_mfma_f32_16x16x32_bf16 v[92:95], v[60:63], v[52:55], v[92:95]
    v_mfma_f32_16x16x32_bf16 v[96:99], v[60:63], v[56:59], v[96:99]
    ds_read_b64_tr_b16 v[60:61], v32 offset:240
    ds_read_b64_tr_b16 v[62:63], v32 offset:4080
    v_mfma_f32_16x16x32_bf16 v[100:103], v[64:67], v[52:55], v[100:103]
    v_mfma_f32_16x16x32_bf16 v[104:107], v[64:67], v[56:59], v[104:107]
    ds_read_b64_tr_b16 v[64:65], v32 offset:248
    ds_read_b64_tr_b16 v[66:67], v32 offset:4088
    v_mfma_f32_16x16x32_bf16 v[108:111], v[52:55], v[68:71], v[108:111]
    v_mfma_f32_16x16x32_bf16 v[112:115], v[56:59], v[68:71], v[112:115]
    ds_read_b64_tr_b16 v[68:69], v35 offset:320
    ds_read_b64_tr_b16 v[70:71], v35 offset:4160
    v_mfma_f32_16x16x32_bf16 v[116:119], v[52:55], v[72:75], v[116:119]
    v_mfma_f32_16x16x32_bf16 v[120:123], v[56:59], v[72:75], v[120:123]
    ds_read_b64_tr_b16 v[72:73], v35 offset:352
    ds_read_b64_tr_b16 v[74:75], v35 offset:4192
    v_mfma_f32_16x16x32_bf16 v[124:127], v[52:55], v[76:79], v[124:127]
    v_mfma_f32_16x16x32_bf16 v[128:131], v[56:59], v[76:79], v[128:131]
    ds_read_b64_tr_b16 v[76:77], v35 offset:384
    ds_read_b64_tr_b16 v[78:79], v35 offset:4224
    v_mfma_f32_16x16x32_bf16 v[132:135], v[52:55], v[80:83], v[132:135]
    v_mfma_f32_16x16x32_bf16 v[136:139], v[56:59], v[80:83], v[136:139]
    ds_read_b64_tr_b16 v[80:81], v35 offset:416
    ds_read_b64_tr_b16 v[82:83], v35 offset:4256
    v_mfma_f32_16x16x32_bf16 v[140:143], v[52:55], v[84:87], v[140:143]
    v_mfma_f32_16x16x32_bf16 v[144:147], v[56:59], v[84:87], v[144:147]
    ds_read_b64_tr_b16 v[84:85], v35 offset:448
    ds_read_b64_tr_b16 v[86:87], v35 offset:4288
    s_waitcnt lgkmcnt(6)
    ds_read_b128 v[52:55], v28 offset:0
    ds_read_b128 v[56:59], v28 offset:2048
    v_mfma_f32_16x16x32_bf16 v[92:95], v[60:63], v[44:47], v[92:95]
    v_mfma_f32_16x16x32_bf16 v[96:99], v[60:63], v[48:51], v[96:99]
    ds_read_b64_tr_b16 v[60:61], v32 offset:15600
    ds_read_b64_tr_b16 v[62:63], v32 offset:19440
    v_mfma_f32_16x16x32_bf16 v[100:103], v[64:67], v[44:47], v[100:103]
    v_mfma_f32_16x16x32_bf16 v[104:107], v[64:67], v[48:51], v[104:107]
    ds_read_b64_tr_b16 v[64:65], v32 offset:15608
    ds_read_b64_tr_b16 v[66:67], v32 offset:19448
    v_mfma_f32_16x16x32_bf16 v[108:111], v[44:47], v[68:71], v[108:111]
    v_mfma_f32_16x16x32_bf16 v[112:115], v[48:51], v[68:71], v[112:115]
    ds_read_b64_tr_b16 v[68:69], v35 offset:15680
    ds_read_b64_tr_b16 v[70:71], v35 offset:19520
    v_mfma_f32_16x16x32_bf16 v[116:119], v[44:47], v[72:75], v[116:119]
    v_mfma_f32_16x16x32_bf16 v[120:123], v[48:51], v[72:75], v[120:123]
    ds_read_b64_tr_b16 v[72:73], v35 offset:15712
    ds_read_b64_tr_b16 v[74:75], v35 offset:19552
    s_waitcnt lgkmcnt(10)
    v_mfma_f32_16x16x32_bf16 v[124:127], v[44:47], v[76:79], v[124:127]
    v_mfma_f32_16x16x32_bf16 v[128:131], v[48:51], v[76:79], v[128:131]
    ds_read_b64_tr_b16 v[76:77], v35 offset:15744
    ds_read_b64_tr_b16 v[78:79], v35 offset:19584
    v_mfma_f32_16x16x32_bf16 v[132:135], v[44:47], v[80:83], v[132:135]
    v_mfma_f32_16x16x32_bf16 v[136:139], v[48:51], v[80:83], v[136:139]
    ds_read_b64_tr_b16 v[80:81], v35 offset:15776
    ds_read_b64_tr_b16 v[82:83], v35 offset:19616
    v_mfma_f32_16x16x32_bf16 v[140:143], v[44:47], v[84:87], v[140:143]
    v_mfma_f32_16x16x32_bf16 v[144:147], v[48:51], v[84:87], v[144:147]
    ds_read_b64_tr_b16 v[84:85], v35 offset:15808
    ds_read_b64_tr_b16 v[86:87], v35 offset:19648
    s_waitcnt lgkmcnt(0)
    s_barrier
    ds_read_b128 v[44:47], v29 offset:0
    ds_read_b128 v[48:51], v29 offset:2048
    v_mfma_f32_16x16x32_bf16 v[92:95], v[60:63], v[52:55], v[92:95]
    v_mfma_f32_16x16x32_bf16 v[96:99], v[60:63], v[56:59], v[96:99]
    ds_read_b64_tr_b16 v[60:61], v33 offset:240
    ds_read_b64_tr_b16 v[62:63], v33 offset:4080
    v_mfma_f32_16x16x32_bf16 v[100:103], v[64:67], v[52:55], v[100:103]
    v_mfma_f32_16x16x32_bf16 v[104:107], v[64:67], v[56:59], v[104:107]
    ds_read_b64_tr_b16 v[64:65], v33 offset:248
    ds_read_b64_tr_b16 v[66:67], v33 offset:4088
    v_mfma_f32_16x16x32_bf16 v[108:111], v[52:55], v[68:71], v[108:111]
    v_mfma_f32_16x16x32_bf16 v[112:115], v[56:59], v[68:71], v[112:115]
    ds_read_b64_tr_b16 v[68:69], v36 offset:320
    ds_read_b64_tr_b16 v[70:71], v36 offset:4160
    v_mfma_f32_16x16x32_bf16 v[116:119], v[52:55], v[72:75], v[116:119]
    v_mfma_f32_16x16x32_bf16 v[120:123], v[56:59], v[72:75], v[120:123]
    ds_read_b64_tr_b16 v[72:73], v36 offset:352
    ds_read_b64_tr_b16 v[74:75], v36 offset:4192
    v_mfma_f32_16x16x32_bf16 v[124:127], v[52:55], v[76:79], v[124:127]
    v_mfma_f32_16x16x32_bf16 v[128:131], v[56:59], v[76:79], v[128:131]
    ds_read_b64_tr_b16 v[76:77], v36 offset:384
    ds_read_b64_tr_b16 v[78:79], v36 offset:4224
    v_mfma_f32_16x16x32_bf16 v[132:135], v[52:55], v[80:83], v[132:135]
    v_mfma_f32_16x16x32_bf16 v[136:139], v[56:59], v[80:83], v[136:139]
    ds_read_b64_tr_b16 v[80:81], v36 offset:416
    ds_read_b64_tr_b16 v[82:83], v36 offset:4256
    v_mfma_f32_16x16x32_bf16 v[140:143], v[52:55], v[84:87], v[140:143]
    v_mfma_f32_16x16x32_bf16 v[144:147], v[56:59], v[84:87], v[144:147]
    ds_read_b64_tr_b16 v[84:85], v36 offset:448
    ds_read_b64_tr_b16 v[86:87], v36 offset:4288
    s_waitcnt lgkmcnt(6)
    ds_read_b128 v[52:55], v30 offset:0
    ds_read_b128 v[56:59], v30 offset:2048
    v_mfma_f32_16x16x32_bf16 v[92:95], v[60:63], v[44:47], v[92:95]
    v_mfma_f32_16x16x32_bf16 v[96:99], v[60:63], v[48:51], v[96:99]
    ds_read_b64_tr_b16 v[60:61], v33 offset:15600
    ds_read_b64_tr_b16 v[62:63], v33 offset:19440
    v_mfma_f32_16x16x32_bf16 v[100:103], v[64:67], v[44:47], v[100:103]
    v_mfma_f32_16x16x32_bf16 v[104:107], v[64:67], v[48:51], v[104:107]
    ds_read_b64_tr_b16 v[64:65], v33 offset:15608
    ds_read_b64_tr_b16 v[66:67], v33 offset:19448
    v_mfma_f32_16x16x32_bf16 v[108:111], v[44:47], v[68:71], v[108:111]
    v_mfma_f32_16x16x32_bf16 v[112:115], v[48:51], v[68:71], v[112:115]
    ds_read_b64_tr_b16 v[68:69], v36 offset:15680
    ds_read_b64_tr_b16 v[70:71], v36 offset:19520
    v_mfma_f32_16x16x32_bf16 v[116:119], v[44:47], v[72:75], v[116:119]
    v_mfma_f32_16x16x32_bf16 v[120:123], v[48:51], v[72:75], v[120:123]
    ds_read_b64_tr_b16 v[72:73], v36 offset:15712
    ds_read_b64_tr_b16 v[74:75], v36 offset:19552
    s_waitcnt lgkmcnt(10)
    v_mfma_f32_16x16x32_bf16 v[124:127], v[44:47], v[76:79], v[124:127]
    v_mfma_f32_16x16x32_bf16 v[128:131], v[48:51], v[76:79], v[128:131]
    ds_read_b64_tr_b16 v[76:77], v36 offset:15744
    ds_read_b64_tr_b16 v[78:79], v36 offset:19584
    v_mfma_f32_16x16x32_bf16 v[132:135], v[44:47], v[80:83], v[132:135]
    v_mfma_f32_16x16x32_bf16 v[136:139], v[48:51], v[80:83], v[136:139]
    ds_read_b64_tr_b16 v[80:81], v36 offset:15776
    ds_read_b64_tr_b16 v[82:83], v36 offset:19616
    v_mfma_f32_16x16x32_bf16 v[140:143], v[44:47], v[84:87], v[140:143]
    v_mfma_f32_16x16x32_bf16 v[144:147], v[48:51], v[84:87], v[144:147]
    ds_read_b64_tr_b16 v[84:85], v36 offset:15808
    ds_read_b64_tr_b16 v[86:87], v36 offset:19648
    s_waitcnt lgkmcnt(0)
    s_barrier
    ds_read_b128 v[44:47], v25 offset:0
    ds_read_b128 v[48:51], v25 offset:2048
    v_mfma_f32_16x16x32_bf16 v[92:95], v[60:63], v[52:55], v[92:95]
    v_mfma_f32_16x16x32_bf16 v[96:99], v[60:63], v[56:59], v[96:99]
    ds_read_b64_tr_b16 v[60:61], v31 offset:240
    ds_read_b64_tr_b16 v[62:63], v31 offset:4080
    v_mfma_f32_16x16x32_bf16 v[100:103], v[64:67], v[52:55], v[100:103]
    v_mfma_f32_16x16x32_bf16 v[104:107], v[64:67], v[56:59], v[104:107]
    ds_read_b64_tr_b16 v[64:65], v31 offset:248
    ds_read_b64_tr_b16 v[66:67], v31 offset:4088
    v_mfma_f32_16x16x32_bf16 v[108:111], v[52:55], v[68:71], v[108:111]
    v_mfma_f32_16x16x32_bf16 v[112:115], v[56:59], v[68:71], v[112:115]
    ds_read_b64_tr_b16 v[68:69], v34 offset:320
    ds_read_b64_tr_b16 v[70:71], v34 offset:4160
    v_mfma_f32_16x16x32_bf16 v[116:119], v[52:55], v[72:75], v[116:119]
    v_mfma_f32_16x16x32_bf16 v[120:123], v[56:59], v[72:75], v[120:123]
    ds_read_b64_tr_b16 v[72:73], v34 offset:352
    ds_read_b64_tr_b16 v[74:75], v34 offset:4192
    v_mfma_f32_16x16x32_bf16 v[124:127], v[52:55], v[76:79], v[124:127]
    v_mfma_f32_16x16x32_bf16 v[128:131], v[56:59], v[76:79], v[128:131]
    ds_read_b64_tr_b16 v[76:77], v34 offset:384
    ds_read_b64_tr_b16 v[78:79], v34 offset:4224
    v_mfma_f32_16x16x32_bf16 v[132:135], v[52:55], v[80:83], v[132:135]
    v_mfma_f32_16x16x32_bf16 v[136:139], v[56:59], v[80:83], v[136:139]
    ds_read_b64_tr_b16 v[80:81], v34 offset:416
    ds_read_b64_tr_b16 v[82:83], v34 offset:4256
    v_mfma_f32_16x16x32_bf16 v[140:143], v[52:55], v[84:87], v[140:143]
    v_mfma_f32_16x16x32_bf16 v[144:147], v[56:59], v[84:87], v[144:147]
    ds_read_b64_tr_b16 v[84:85], v34 offset:448
    ds_read_b64_tr_b16 v[86:87], v34 offset:4288
    s_waitcnt lgkmcnt(6)
    ds_read_b128 v[52:55], v26 offset:0
    ds_read_b128 v[56:59], v26 offset:2048
    v_mfma_f32_16x16x32_bf16 v[92:95], v[60:63], v[44:47], v[92:95]
    v_mfma_f32_16x16x32_bf16 v[96:99], v[60:63], v[48:51], v[96:99]
    ds_read_b64_tr_b16 v[60:61], v31 offset:15600
    ds_read_b64_tr_b16 v[62:63], v31 offset:19440
    v_mfma_f32_16x16x32_bf16 v[100:103], v[64:67], v[44:47], v[100:103]
    v_mfma_f32_16x16x32_bf16 v[104:107], v[64:67], v[48:51], v[104:107]
    ds_read_b64_tr_b16 v[64:65], v31 offset:15608
    ds_read_b64_tr_b16 v[66:67], v31 offset:19448
    v_mfma_f32_16x16x32_bf16 v[108:111], v[44:47], v[68:71], v[108:111]
    v_mfma_f32_16x16x32_bf16 v[112:115], v[48:51], v[68:71], v[112:115]
    ds_read_b64_tr_b16 v[68:69], v34 offset:15680
    ds_read_b64_tr_b16 v[70:71], v34 offset:19520
    v_mfma_f32_16x16x32_bf16 v[116:119], v[44:47], v[72:75], v[116:119]
    v_mfma_f32_16x16x32_bf16 v[120:123], v[48:51], v[72:75], v[120:123]
    ds_read_b64_tr_b16 v[72:73], v34 offset:15712
    ds_read_b64_tr_b16 v[74:75], v34 offset:19552
    s_waitcnt lgkmcnt(10)
    v_mfma_f32_16x16x32_bf16 v[124:127], v[44:47], v[76:79], v[124:127]
    v_mfma_f32_16x16x32_bf16 v[128:131], v[48:51], v[76:79], v[128:131]
    ds_read_b64_tr_b16 v[76:77], v34 offset:15744
    ds_read_b64_tr_b16 v[78:79], v34 offset:19584
    v_mfma_f32_16x16x32_bf16 v[132:135], v[44:47], v[80:83], v[132:135]
    v_mfma_f32_16x16x32_bf16 v[136:139], v[48:51], v[80:83], v[136:139]
    ds_read_b64_tr_b16 v[80:81], v34 offset:15776
    ds_read_b64_tr_b16 v[82:83], v34 offset:19616
    v_mfma_f32_16x16x32_bf16 v[140:143], v[44:47], v[84:87], v[140:143]
    v_mfma_f32_16x16x32_bf16 v[144:147], v[48:51], v[84:87], v[144:147]
    ds_read_b64_tr_b16 v[84:85], v34 offset:15808
    ds_read_b64_tr_b16 v[86:87], v34 offset:19648
    s_waitcnt lgkmcnt(0)
    s_barrier
    ds_read_b128 v[44:47], v27 offset:0
    ds_read_b128 v[48:51], v27 offset:2048
    v_mfma_f32_16x16x32_bf16 v[92:95], v[60:63], v[52:55], v[92:95]
    v_mfma_f32_16x16x32_bf16 v[96:99], v[60:63], v[56:59], v[96:99]
    ds_read_b64_tr_b16 v[60:61], v32 offset:240
    ds_read_b64_tr_b16 v[62:63], v32 offset:4080
    v_mfma_f32_16x16x32_bf16 v[100:103], v[64:67], v[52:55], v[100:103]
    v_mfma_f32_16x16x32_bf16 v[104:107], v[64:67], v[56:59], v[104:107]
    ds_read_b64_tr_b16 v[64:65], v32 offset:248
    ds_read_b64_tr_b16 v[66:67], v32 offset:4088
    v_mfma_f32_16x16x32_bf16 v[108:111], v[52:55], v[68:71], v[108:111]
    v_mfma_f32_16x16x32_bf16 v[112:115], v[56:59], v[68:71], v[112:115]
    ds_read_b64_tr_b16 v[68:69], v35 offset:320
    ds_read_b64_tr_b16 v[70:71], v35 offset:4160
    v_mfma_f32_16x16x32_bf16 v[116:119], v[52:55], v[72:75], v[116:119]
    v_mfma_f32_16x16x32_bf16 v[120:123], v[56:59], v[72:75], v[120:123]
    ds_read_b64_tr_b16 v[72:73], v35 offset:352
    ds_read_b64_tr_b16 v[74:75], v35 offset:4192
    v_mfma_f32_16x16x32_bf16 v[124:127], v[52:55], v[76:79], v[124:127]
    v_mfma_f32_16x16x32_bf16 v[128:131], v[56:59], v[76:79], v[128:131]
    ds_read_b64_tr_b16 v[76:77], v35 offset:384
    ds_read_b64_tr_b16 v[78:79], v35 offset:4224
    v_mfma_f32_16x16x32_bf16 v[132:135], v[52:55], v[80:83], v[132:135]
    v_mfma_f32_16x16x32_bf16 v[136:139], v[56:59], v[80:83], v[136:139]
    ds_read_b64_tr_b16 v[80:81], v35 offset:416
    ds_read_b64_tr_b16 v[82:83], v35 offset:4256
    v_mfma_f32_16x16x32_bf16 v[140:143], v[52:55], v[84:87], v[140:143]
    v_mfma_f32_16x16x32_bf16 v[144:147], v[56:59], v[84:87], v[144:147]
    ds_read_b64_tr_b16 v[84:85], v35 offset:448
    ds_read_b64_tr_b16 v[86:87], v35 offset:4288
    s_waitcnt lgkmcnt(6)
    ds_read_b128 v[52:55], v28 offset:0
    ds_read_b128 v[56:59], v28 offset:2048
    v_mfma_f32_16x16x32_bf16 v[92:95], v[60:63], v[44:47], v[92:95]
    v_mfma_f32_16x16x32_bf16 v[96:99], v[60:63], v[48:51], v[96:99]
    ds_read_b64_tr_b16 v[60:61], v32 offset:15600
    ds_read_b64_tr_b16 v[62:63], v32 offset:19440
    v_mfma_f32_16x16x32_bf16 v[100:103], v[64:67], v[44:47], v[100:103]
    v_mfma_f32_16x16x32_bf16 v[104:107], v[64:67], v[48:51], v[104:107]
    ds_read_b64_tr_b16 v[64:65], v32 offset:15608
    ds_read_b64_tr_b16 v[66:67], v32 offset:19448
    v_mfma_f32_16x16x32_bf16 v[108:111], v[44:47], v[68:71], v[108:111]
    v_mfma_f32_16x16x32_bf16 v[112:115], v[48:51], v[68:71], v[112:115]
    ds_read_b64_tr_b16 v[68:69], v35 offset:15680
    ds_read_b64_tr_b16 v[70:71], v35 offset:19520
    v_mfma_f32_16x16x32_bf16 v[116:119], v[44:47], v[72:75], v[116:119]
    v_mfma_f32_16x16x32_bf16 v[120:123], v[48:51], v[72:75], v[120:123]
    ds_read_b64_tr_b16 v[72:73], v35 offset:15712
    ds_read_b64_tr_b16 v[74:75], v35 offset:19552
    s_waitcnt lgkmcnt(10)
    v_mfma_f32_16x16x32_bf16 v[124:127], v[44:47], v[76:79], v[124:127]
    v_mfma_f32_16x16x32_bf16 v[128:131], v[48:51], v[76:79], v[128:131]
    ds_read_b64_tr_b16 v[76:77], v35 offset:15744
    ds_read_b64_tr_b16 v[78:79], v35 offset:19584
    v_mfma_f32_16x16x32_bf16 v[132:135], v[44:47], v[80:83], v[132:135]
    v_mfma_f32_16x16x32_bf16 v[136:139], v[48:51], v[80:83], v[136:139]
    ds_read_b64_tr_b16 v[80:81], v35 offset:15776
    ds_read_b64_tr_b16 v[82:83], v35 offset:19616
    v_mfma_f32_16x16x32_bf16 v[140:143], v[44:47], v[84:87], v[140:143]
    v_mfma_f32_16x16x32_bf16 v[144:147], v[48:51], v[84:87], v[144:147]
    ds_read_b64_tr_b16 v[84:85], v35 offset:15808
    ds_read_b64_tr_b16 v[86:87], v35 offset:19648
    s_waitcnt lgkmcnt(0)
    s_barrier
    ds_read_b128 v[44:47], v29 offset:0
    ds_read_b128 v[48:51], v29 offset:2048
    v_mfma_f32_16x16x32_bf16 v[92:95], v[60:63], v[52:55], v[92:95]
    v_mfma_f32_16x16x32_bf16 v[96:99], v[60:63], v[56:59], v[96:99]
    ds_read_b64_tr_b16 v[60:61], v33 offset:240
    ds_read_b64_tr_b16 v[62:63], v33 offset:4080
    v_mfma_f32_16x16x32_bf16 v[100:103], v[64:67], v[52:55], v[100:103]
    v_mfma_f32_16x16x32_bf16 v[104:107], v[64:67], v[56:59], v[104:107]
    ds_read_b64_tr_b16 v[64:65], v33 offset:248
    ds_read_b64_tr_b16 v[66:67], v33 offset:4088
    v_mfma_f32_16x16x32_bf16 v[108:111], v[52:55], v[68:71], v[108:111]
    v_mfma_f32_16x16x32_bf16 v[112:115], v[56:59], v[68:71], v[112:115]
    ds_read_b64_tr_b16 v[68:69], v36 offset:320
    ds_read_b64_tr_b16 v[70:71], v36 offset:4160
    v_mfma_f32_16x16x32_bf16 v[116:119], v[52:55], v[72:75], v[116:119]
    v_mfma_f32_16x16x32_bf16 v[120:123], v[56:59], v[72:75], v[120:123]
    ds_read_b64_tr_b16 v[72:73], v36 offset:352
    ds_read_b64_tr_b16 v[74:75], v36 offset:4192
    v_mfma_f32_16x16x32_bf16 v[124:127], v[52:55], v[76:79], v[124:127]
    v_mfma_f32_16x16x32_bf16 v[128:131], v[56:59], v[76:79], v[128:131]
    ds_read_b64_tr_b16 v[76:77], v36 offset:384
    ds_read_b64_tr_b16 v[78:79], v36 offset:4224
    v_mfma_f32_16x16x32_bf16 v[132:135], v[52:55], v[80:83], v[132:135]
    v_mfma_f32_16x16x32_bf16 v[136:139], v[56:59], v[80:83], v[136:139]
    ds_read_b64_tr_b16 v[80:81], v36 offset:416
    ds_read_b64_tr_b16 v[82:83], v36 offset:4256
    v_mfma_f32_16x16x32_bf16 v[140:143], v[52:55], v[84:87], v[140:143]
    v_mfma_f32_16x16x32_bf16 v[144:147], v[56:59], v[84:87], v[144:147]
    ds_read_b64_tr_b16 v[84:85], v36 offset:448
    ds_read_b64_tr_b16 v[86:87], v36 offset:4288
    s_waitcnt lgkmcnt(6)
    ds_read_b128 v[52:55], v30 offset:0
    ds_read_b128 v[56:59], v30 offset:2048
    v_mfma_f32_16x16x32_bf16 v[92:95], v[60:63], v[44:47], v[92:95]
    v_mfma_f32_16x16x32_bf16 v[96:99], v[60:63], v[48:51], v[96:99]
    ds_read_b64_tr_b16 v[60:61], v33 offset:15600
    ds_read_b64_tr_b16 v[62:63], v33 offset:19440
    v_mfma_f32_16x16x32_bf16 v[100:103], v[64:67], v[44:47], v[100:103]
    v_mfma_f32_16x16x32_bf16 v[104:107], v[64:67], v[48:51], v[104:107]
    ds_read_b64_tr_b16 v[64:65], v33 offset:15608
    ds_read_b64_tr_b16 v[66:67], v33 offset:19448
    v_mfma_f32_16x16x32_bf16 v[108:111], v[44:47], v[68:71], v[108:111]
    v_mfma_f32_16x16x32_bf16 v[112:115], v[48:51], v[68:71], v[112:115]
    ds_read_b64_tr_b16 v[68:69], v36 offset:15680
    ds_read_b64_tr_b16 v[70:71], v36 offset:19520
    v_mfma_f32_16x16x32_bf16 v[116:119], v[44:47], v[72:75], v[116:119]
    v_mfma_f32_16x16x32_bf16 v[120:123], v[48:51], v[72:75], v[120:123]
    ds_read_b64_tr_b16 v[72:73], v36 offset:15712
    ds_read_b64_tr_b16 v[74:75], v36 offset:19552
    s_waitcnt lgkmcnt(10)
    v_mfma_f32_16x16x32_bf16 v[124:127], v[44:47], v[76:79], v[124:127]
    v_mfma_f32_16x16x32_bf16 v[128:131], v[48:51], v[76:79], v[128:131]
    ds_read_b64_tr_b16 v[76:77], v36 offset:15744
    ds_read_b64_tr_b16 v[78:79], v36 offset:19584
    v_mfma_f32_16x16x32_bf16 v[132:135], v[44:47], v[80:83], v[132:135]
    v_mfma_f32_16x16x32_bf16 v[136:139], v[48:51], v[80:83], v[136:139]
    ds_read_b64_tr_b16 v[80:81], v36 offset:15776
    ds_read_b64_tr_b16 v[82:83], v36 offset:19616
    v_mfma_f32_16x16x32_bf16 v[140:143], v[44:47], v[84:87], v[140:143]
    v_mfma_f32_16x16x32_bf16 v[144:147], v[48:51], v[84:87], v[144:147]
    ds_read_b64_tr_b16 v[84:85], v36 offset:15808
    ds_read_b64_tr_b16 v[86:87], v36 offset:19648
    s_waitcnt lgkmcnt(0)
    s_barrier
    ds_read_b128 v[44:47], v25 offset:0
    ds_read_b128 v[48:51], v25 offset:2048
    v_mfma_f32_16x16x32_bf16 v[92:95], v[60:63], v[52:55], v[92:95]
    v_mfma_f32_16x16x32_bf16 v[96:99], v[60:63], v[56:59], v[96:99]
    ds_read_b64_tr_b16 v[60:61], v31 offset:240
    ds_read_b64_tr_b16 v[62:63], v31 offset:4080
    v_mfma_f32_16x16x32_bf16 v[100:103], v[64:67], v[52:55], v[100:103]
    v_mfma_f32_16x16x32_bf16 v[104:107], v[64:67], v[56:59], v[104:107]
    ds_read_b64_tr_b16 v[64:65], v31 offset:248
    ds_read_b64_tr_b16 v[66:67], v31 offset:4088
    v_mfma_f32_16x16x32_bf16 v[108:111], v[52:55], v[68:71], v[108:111]
    v_mfma_f32_16x16x32_bf16 v[112:115], v[56:59], v[68:71], v[112:115]
    ds_read_b64_tr_b16 v[68:69], v34 offset:320
    ds_read_b64_tr_b16 v[70:71], v34 offset:4160
    v_mfma_f32_16x16x32_bf16 v[116:119], v[52:55], v[72:75], v[116:119]
    v_mfma_f32_16x16x32_bf16 v[120:123], v[56:59], v[72:75], v[120:123]
    ds_read_b64_tr_b16 v[72:73], v34 offset:352
    ds_read_b64_tr_b16 v[74:75], v34 offset:4192
    v_mfma_f32_16x16x32_bf16 v[124:127], v[52:55], v[76:79], v[124:127]
    v_mfma_f32_16x16x32_bf16 v[128:131], v[56:59], v[76:79], v[128:131]
    ds_read_b64_tr_b16 v[76:77], v34 offset:384
    ds_read_b64_tr_b16 v[78:79], v34 offset:4224
    v_mfma_f32_16x16x32_bf16 v[132:135], v[52:55], v[80:83], v[132:135]
    v_mfma_f32_16x16x32_bf16 v[136:139], v[56:59], v[80:83], v[136:139]
    ds_read_b64_tr_b16 v[80:81], v34 offset:416
    ds_read_b64_tr_b16 v[82:83], v34 offset:4256
    v_mfma_f32_16x16x32_bf16 v[140:143], v[52:55], v[84:87], v[140:143]
    v_mfma_f32_16x16x32_bf16 v[144:147], v[56:59], v[84:87], v[144:147]
    ds_read_b64_tr_b16 v[84:85], v34 offset:448
    ds_read_b64_tr_b16 v[86:87], v34 offset:4288
    s_barrier
    s_waitcnt lgkmcnt(6)
    ds_read_b128 v[52:55], v26 offset:0
    ds_read_b128 v[56:59], v26 offset:2048
    v_mfma_f32_16x16x32_bf16 v[92:95], v[60:63], v[44:47], v[92:95]
    v_mfma_f32_16x16x32_bf16 v[96:99], v[60:63], v[48:51], v[96:99]
    ds_read_b64_tr_b16 v[60:61], v31 offset:15600
    ds_read_b64_tr_b16 v[62:63], v31 offset:19440
    v_mfma_f32_16x16x32_bf16 v[100:103], v[64:67], v[44:47], v[100:103]
    v_mfma_f32_16x16x32_bf16 v[104:107], v[64:67], v[48:51], v[104:107]
    ds_read_b64_tr_b16 v[64:65], v31 offset:15608
    ds_read_b64_tr_b16 v[66:67], v31 offset:19448
    v_mfma_f32_16x16x32_bf16 v[108:111], v[44:47], v[68:71], v[108:111]
    v_mfma_f32_16x16x32_bf16 v[112:115], v[48:51], v[68:71], v[112:115]
    ds_read_b64_tr_b16 v[68:69], v34 offset:15680
    ds_read_b64_tr_b16 v[70:71], v34 offset:19520
    v_mfma_f32_16x16x32_bf16 v[116:119], v[44:47], v[72:75], v[116:119]
    v_mfma_f32_16x16x32_bf16 v[120:123], v[48:51], v[72:75], v[120:123]
    ds_read_b64_tr_b16 v[72:73], v34 offset:15712
    ds_read_b64_tr_b16 v[74:75], v34 offset:19552
    s_waitcnt lgkmcnt(10)
    v_mfma_f32_16x16x32_bf16 v[124:127], v[44:47], v[76:79], v[124:127]
    v_mfma_f32_16x16x32_bf16 v[128:131], v[48:51], v[76:79], v[128:131]
    ds_read_b64_tr_b16 v[76:77], v34 offset:15744
    ds_read_b64_tr_b16 v[78:79], v34 offset:19584
    v_mfma_f32_16x16x32_bf16 v[132:135], v[44:47], v[80:83], v[132:135]
    v_mfma_f32_16x16x32_bf16 v[136:139], v[48:51], v[80:83], v[136:139]
    ds_read_b64_tr_b16 v[80:81], v34 offset:15776
    ds_read_b64_tr_b16 v[82:83], v34 offset:19616
    v_mfma_f32_16x16x32_bf16 v[140:143], v[44:47], v[84:87], v[140:143]
    v_mfma_f32_16x16x32_bf16 v[144:147], v[48:51], v[84:87], v[144:147]
    ds_read_b64_tr_b16 v[84:85], v34 offset:15808
    ds_read_b64_tr_b16 v[86:87], v34 offset:19648
    s_waitcnt lgkmcnt(0)
    s_barrier
    v_mfma_f32_16x16x32_bf16 v[92:95], v[60:63], v[52:55], v[92:95]
    v_mfma_f32_16x16x32_bf16 v[96:99], v[60:63], v[56:59], v[96:99]
    v_mfma_f32_16x16x32_bf16 v[100:103], v[64:67], v[52:55], v[100:103]
    v_mfma_f32_16x16x32_bf16 v[104:107], v[64:67], v[56:59], v[104:107]
    v_mfma_f32_16x16x32_bf16 v[108:111], v[52:55], v[68:71], v[108:111]
    v_mfma_f32_16x16x32_bf16 v[112:115], v[56:59], v[68:71], v[112:115]
    v_mfma_f32_16x16x32_bf16 v[116:119], v[52:55], v[72:75], v[116:119]
    v_mfma_f32_16x16x32_bf16 v[120:123], v[56:59], v[72:75], v[120:123]
    v_mfma_f32_16x16x32_bf16 v[124:127], v[52:55], v[76:79], v[124:127]
    v_mfma_f32_16x16x32_bf16 v[128:131], v[56:59], v[76:79], v[128:131]
    v_mfma_f32_16x16x32_bf16 v[132:135], v[52:55], v[80:83], v[132:135]
    v_mfma_f32_16x16x32_bf16 v[136:139], v[56:59], v[80:83], v[136:139]
    v_mfma_f32_16x16x32_bf16 v[140:143], v[52:55], v[84:87], v[140:143]
    v_mfma_f32_16x16x32_bf16 v[144:147], v[56:59], v[84:87], v[144:147]
    v_cvt_pk_bf16_f32 v92, v92, v93
    v_cvt_pk_bf16_f32 v93, v94, v95
    v_cvt_pk_bf16_f32 v94, v100, v101
    v_cvt_pk_bf16_f32 v95, v102, v103
    ds_write_b128 v37, v[92:95] offset:20480
    v_cvt_pk_bf16_f32 v96, v96, v97
    v_cvt_pk_bf16_f32 v97, v98, v99
    v_cvt_pk_bf16_f32 v98, v104, v105
    v_cvt_pk_bf16_f32 v99, v106, v107
    ds_write_b128 v37, v[96:99] offset:20544
    v_cvt_pk_bf16_f32 v108, v108, v109
    v_cvt_pk_bf16_f32 v109, v110, v111
    v_cvt_pk_bf16_f32 v110, v112, v113
    v_cvt_pk_bf16_f32 v111, v114, v115
    ds_write_b128 v38, v[108:111]
    v_cvt_pk_bf16_f32 v116, v116, v117
    v_cvt_pk_bf16_f32 v117, v118, v119
    v_cvt_pk_bf16_f32 v118, v120, v121
    v_cvt_pk_bf16_f32 v119, v122, v123
    ds_write_b128 v39, v[116:119]
    v_cvt_pk_bf16_f32 v124, v124, v125
    v_cvt_pk_bf16_f32 v125, v126, v127
    v_cvt_pk_bf16_f32 v126, v128, v129
    v_cvt_pk_bf16_f32 v127, v130, v131
    ds_write_b128 v40, v[124:127]
    v_cvt_pk_bf16_f32 v132, v132, v133
    v_cvt_pk_bf16_f32 v133, v134, v135
    v_cvt_pk_bf16_f32 v134, v136, v137
    v_cvt_pk_bf16_f32 v135, v138, v139
    ds_write_b128 v41, v[132:135]
    v_cvt_pk_bf16_f32 v140, v140, v141
    v_cvt_pk_bf16_f32 v141, v142, v143
    v_cvt_pk_bf16_f32 v142, v144, v145
    v_cvt_pk_bf16_f32 v143, v146, v147
    ds_write_b128 v42, v[140:143]
    s_waitcnt lgkmcnt(0)
    s_barrier
    ds_read_b128 v[44:47], v21 offset:0
    ds_read_b128 v[48:51], v21 offset:1024
    ds_read_b128 v[52:55], v21 offset:2048
    ds_read_b128 v[56:59], v21 offset:3072
    ds_read_b128 v[60:63], v21 offset:4096
    ds_read_b128 v[64:67], v21 offset:5120
    ds_read_b128 v[68:71], v21 offset:6144
    ds_read_b128 v[72:75], v21 offset:7168
    ds_read_b128 v[76:79], v21 offset:8192
    ds_read_b128 v[80:83], v21 offset:9216
    s_waitcnt lgkmcnt(9)
    buffer_store_dwordx4 v[44:47], v17, s[16:19], s56 offen offset:0 sc1
    s_waitcnt lgkmcnt(8)
    buffer_store_dwordx4 v[48:51], v17, s[16:19], s56 offen offset:1024 sc1
    s_waitcnt lgkmcnt(7)
    buffer_store_dwordx4 v[52:55], v17, s[16:19], s56 offen offset:2048 sc1
    s_waitcnt lgkmcnt(6)
    buffer_store_dwordx4 v[56:59], v17, s[16:19], s56 offen offset:3072 sc1
    s_add_u32 s56, s56, 4096
    s_waitcnt lgkmcnt(5)
    buffer_store_dwordx4 v[60:63], v17, s[16:19], s56 offen offset:0 sc1
    s_waitcnt lgkmcnt(4)
    buffer_store_dwordx4 v[64:67], v17, s[16:19], s56 offen offset:1024 sc1
    s_waitcnt lgkmcnt(3)
    buffer_store_dwordx4 v[68:71], v17, s[16:19], s56 offen offset:2048 sc1
    s_waitcnt lgkmcnt(2)
    buffer_store_dwordx4 v[72:75], v17, s[16:19], s56 offen offset:3072 sc1
    s_add_u32 s56, s56, 4096
    s_waitcnt lgkmcnt(1)
    buffer_store_dwordx4 v[76:79], v17, s[16:19], s56 offen offset:0 sc1
    s_waitcnt lgkmcnt(0)
    buffer_store_dwordx4 v[80:83], v17, s[16:19], s56 offen offset:1024 sc1
    s_nop 1
concat_heads__mha_block__mha_block__prompt_kernel_p2:
    v_mov_b32 v68, 0
    v_mov_b32 v69, 0
    v_mov_b32 v70, 0
    v_mov_b32 v71, 0
    v_mov_b32 v72, 0
    v_mov_b32 v73, 0
    v_mov_b32 v74, 0
    v_mov_b32 v75, 0
    v_mov_b32 v76, 0
    v_mov_b32 v77, 0
    v_mov_b32 v78, 0
    v_mov_b32 v79, 0
    v_mov_b32 v80, 0
    v_mov_b32 v81, 0
    v_mov_b32 v82, 0
    v_mov_b32 v83, 0
    v_mov_b32 v84, 0
    v_mov_b32 v85, 0
    v_mov_b32 v86, 0
    v_mov_b32 v87, 0
    v_mov_b32 v88, 0
    v_mov_b32 v89, 0
    v_mov_b32 v90, 0
    v_mov_b32 v91, 0
    v_mov_b32 v92, 0
    v_mov_b32 v93, 0
    v_mov_b32 v94, 0
    v_mov_b32 v95, 0
    v_mov_b32 v96, 0
    v_mov_b32 v97, 0
    v_mov_b32 v98, 0
    v_mov_b32 v99, 0
    v_mov_b32 v64, 0
    v_mov_b32 v65, 0
    v_mov_b32 v66, 0
    v_mov_b32 v67, 0
    s_mov_b32 s44, 0
    s_mov_b32 s45, 0
    s_mov_b32 s36, 81920
    v_add_u32 v9, s36, v12
    v_mad_u32_u24 v10, v15, s36, v13
    v_mad_u32_u24 v11, v16, s36, v14
    s_mov_b32 s36, 40960
    v_add_u32 v132, s36, v12
    v_mad_u32_u24 v133, v15, s36, v13
    v_mad_u32_u24 v134, v16, s36, v14
    s_waitcnt lgkmcnt(0)
    s_barrier
    ds_read_b128 v[28:31], v19 offset:0
    ds_read_b64 v[36:37], v20 offset:0
    ds_read_b128 v[32:35], v19 offset:1280
    ds_read_b64 v[38:39], v20 offset:1280
    ds_read_b128 v[40:43], v12 offset:0
    ds_read_b64 v[48:49], v13 offset:0
    ds_read_b128 v[44:47], v12 offset:2560
    ds_read_b64 v[50:51], v13 offset:2560
    ds_read_b128 v[52:55], v14 offset:0
    ds_read_b128 v[60:63], v14 offset:640
    s_waitcnt lgkmcnt(4)
    v_cndmask_b32_e64 v36, v36, 0, s[42:43]
    v_cndmask_b32_e64 v37, v37, 0, s[42:43]
    v_cndmask_b32_e64 v38, v38, 0, s[42:43]
    v_cndmask_b32_e64 v39, v39, 0, s[42:43]
    v_mfma_f32_32x32x16_bf16 v[100:115], v[40:43], v[28:31], 0
    v_mfma_f32_32x32x8_bf16 v[100:115], v[48:49], v[36:37], v[100:115]
    v_mfma_f32_32x32x16_bf16 v[116:131], v[40:43], v[32:35], 0
    v_mfma_f32_32x32x8_bf16 v[116:131], v[48:49], v[38:39], v[116:131]
    s_nop 9
    v_max3_f32 v2, v100, v101, v102
    v_max3_f32 v2, v2, v103, v104
    v_max3_f32 v2, v2, v105, v106
    v_max3_f32 v2, v2, v107, v108
    v_max3_f32 v2, v2, v109, v110
    v_max3_f32 v2, v2, v111, v112
    v_max3_f32 v2, v2, v113, v114
    v_max_f32 v2, v2, v115
    v_mov_b32 v3, v2
    s_nop 1
    v_permlane32_swap_b32 v2, v3
    s_nop 1
    v_max_f32 v2, v2, v3
    v_sub_f32 v2, 0, v2
    v_and_b32 v3, 0xffff0000, v2
    v_sub_f32 v2, v2, v3
    v_and_b32 v4, 0xffff0000, v2
    v_sub_f32 v2, v2, v4
    v_lshrrev_b32 v3, 16, v3
    v_or_b32 v3, v3, v4
    v_lshrrev_b32 v2, 16, v2
    v_cndmask_b32_e64 v36, v36, v3, s[42:43]
    v_cndmask_b32_e64 v37, v37, v2, s[42:43]
    v_mfma_f32_32x32x16_bf16 v[100:115], v[40:43], v[28:31], 0
    s_nop 0
    v_mfma_f32_32x32x8_bf16 v[100:115], v[48:49], v[36:37], v[100:115]
    s_nop 1
    v_max3_f32 v2, v116, v117, v118
    v_max3_f32 v2, v2, v119, v120
    v_max3_f32 v2, v2, v121, v122
    v_max3_f32 v2, v2, v123, v124
    v_max3_f32 v2, v2, v125, v126
    v_max3_f32 v2, v2, v127, v128
    v_max3_f32 v2, v2, v129, v130
    v_max_f32 v2, v2, v131
    v_mov_b32 v3, v2
    s_nop 1
    v_permlane32_swap_b32 v2, v3
    s_nop 1
    v_max_f32 v2, v2, v3
    v_sub_f32 v2, 0, v2
    v_and_b32 v3, 0xffff0000, v2
    v_sub_f32 v2, v2, v3
    v_and_b32 v4, 0xffff0000, v2
    v_sub_f32 v2, v2, v4
    v_lshrrev_b32 v3, 16, v3
    v_or_b32 v3, v3, v4
    v_lshrrev_b32 v2, 16, v2
    v_cndmask_b32_e64 v38, v38, v3, s[42:43]
    v_cndmask_b32_e64 v39, v39, v2, s[42:43]
    v_mov_b32 v124, 0
    v_mov_b32 v125, 0
    v_mov_b32 v126, 0
    v_mov_b32 v127, 0
    v_mov_b32 v128, 0
    v_mov_b32 v129, 0
    v_mov_b32 v130, 0
    v_mov_b32 v131, 0
    s_lshl_b32 s36, s33, 3
    s_add_u32 s36, s36, s35
    s_lshl_b32 s36, s36, 6
    s_add_u32 s36, s36, s34
    s_lshl_b32 s36, s36, 2
    s_add_u32 s57, s36, 15728640
    s_mov_b64 exec, 1
    v_mov_b32 v2, 1
    v_mov_b32 v4, 122892
    v_mov_b32 v3, s61
    v_mov_b32 v5, s57
    s_waitcnt vmcnt(0)
    ds_add_rtn_u32 v2, v4, v2
    s_waitcnt lgkmcnt(0)
    v_readfirstlane_b32 s36, v2
    s_cmp_eq_u32 s36, 7
    s_cbranch_scc0 concat_heads__mha_block__mha_block__prompt_kernel_nl1
    buffer_store_dword v3, v5, s[16:19], 0 offen sc1
concat_heads__mha_block__mha_block__prompt_kernel_nl1:
    s_mov_b64 exec, -1
.p2align 6
concat_heads__mha_block__mha_block__prompt_kernel_loop:
    s_setprio 3
    v_exp_f32 v100, v100
    v_exp_f32 v101, v101
    v_smfmac_f32_32x32x32_bf16 v[84:99], v[64:67], v[124:131], v8
    ds_read_b128 v[56:59], v14 offset:2560
    ds_read_b128 v[64:67], v14 offset:3200
    v_exp_f32 v102, v102
    v_exp_f32 v103, v103
    v_exp_f32 v104, v104
    v_exp_f32 v105, v105
    v_mfma_f32_32x32x16_bf16 v[116:131], v[40:43], v[32:35], 0
    v_exp_f32 v106, v106
    v_exp_f32 v107, v107
    v_exp_f32 v108, v108
    v_exp_f32 v109, v109
    v_mfma_f32_32x32x8_bf16 v[116:131], v[48:49], v[38:39], v[116:131]
    v_exp_f32 v110, v110
    v_exp_f32 v111, v111
    v_exp_f32 v112, v112
    v_exp_f32 v113, v113
    v_smfmac_f32_32x32x32_bf16 v[68:83], v[52:55], v[100:107], v8
    s_waitcnt lgkmcnt(2)
    v_exp_f32 v114, v114
    v_exp_f32 v115, v115
    s_setprio 2
    v_exp_f32 v116, v116
    v_exp_f32 v117, v117
    v_smfmac_f32_32x32x32_bf16 v[68:83], v[60:63], v[108:115], v8
    ds_read_b128 v[40:43], v12 offset:5120
    ds_read_b64 v[48:49], v13 offset:5120
    v_exp_f32 v118, v118
    v_exp_f32 v119, v119
    v_exp_f32 v120, v120
    v_exp_f32 v121, v121
    v_mfma_f32_32x32x16_bf16 v[100:115], v[44:47], v[28:31], 0
    v_exp_f32 v122, v122
    v_exp_f32 v123, v123
    v_exp_f32 v124, v124
    v_exp_f32 v125, v125
    v_mfma_f32_32x32x8_bf16 v[100:115], v[50:51], v[36:37], v[100:115]
    v_exp_f32 v126, v126
    v_exp_f32 v127, v127
    v_exp_f32 v128, v128
    v_exp_f32 v129, v129
    v_smfmac_f32_32x32x32_bf16 v[84:99], v[52:55], v[116:123], v8
    s_waitcnt lgkmcnt(2)
    v_exp_f32 v130, v130
    v_exp_f32 v131, v131
    s_setprio 1
    v_exp_f32 v100, v100
    v_exp_f32 v101, v101
    v_smfmac_f32_32x32x32_bf16 v[84:99], v[60:63], v[124:131], v8
    ds_read_b128 v[52:55], v14 offset:5120
    ds_read_b128 v[60:63], v14 offset:5760
    v_exp_f32 v102, v102
    v_exp_f32 v103, v103
    v_exp_f32 v104, v104
    v_exp_f32 v105, v105
    v_mfma_f32_32x32x16_bf16 v[116:131], v[44:47], v[32:35], 0
    v_exp_f32 v106, v106
    v_exp_f32 v107, v107
    v_exp_f32 v108, v108
    v_exp_f32 v109, v109
    v_mfma_f32_32x32x8_bf16 v[116:131], v[50:51], v[38:39], v[116:131]
    v_exp_f32 v110, v110
    v_exp_f32 v111, v111
    v_exp_f32 v112, v112
    v_exp_f32 v113, v113
    v_smfmac_f32_32x32x32_bf16 v[68:83], v[56:59], v[100:107], v8
    s_waitcnt lgkmcnt(2)
    v_exp_f32 v114, v114
    v_exp_f32 v115, v115
    v_exp_f32 v116, v116
    v_exp_f32 v117, v117
    v_smfmac_f32_32x32x32_bf16 v[68:83], v[64:67], v[108:115], v8
    ds_read_b128 v[44:47], v12 offset:7680
    ds_read_b64 v[50:51], v13 offset:7680
    v_exp_f32 v118, v118
    v_exp_f32 v119, v119
    v_exp_f32 v120, v120
    v_exp_f32 v121, v121
    v_mfma_f32_32x32x16_bf16 v[100:115], v[40:43], v[28:31], 0
    v_exp_f32 v122, v122
    v_exp_f32 v123, v123
    v_exp_f32 v124, v124
    v_exp_f32 v125, v125
    v_mfma_f32_32x32x8_bf16 v[100:115], v[48:49], v[36:37], v[100:115]
    v_exp_f32 v126, v126
    v_exp_f32 v127, v127
    v_exp_f32 v128, v128
    v_exp_f32 v129, v129
    v_smfmac_f32_32x32x32_bf16 v[84:99], v[56:59], v[116:123], v8
    s_waitcnt lgkmcnt(2)
    v_exp_f32 v130, v130
    v_exp_f32 v131, v131
    s_setprio 0
    v_exp_f32 v100, v100
    v_exp_f32 v101, v101
    v_smfmac_f32_32x32x32_bf16 v[84:99], v[64:67], v[124:131], v8
    ds_read_b128 v[56:59], v14 offset:7680
    ds_read_b128 v[64:67], v14 offset:8320
    v_exp_f32 v102, v102
    v_exp_f32 v103, v103
    v_exp_f32 v104, v104
    v_exp_f32 v105, v105
    v_mfma_f32_32x32x16_bf16 v[116:131], v[40:43], v[32:35], 0
    v_exp_f32 v106, v106
    v_exp_f32 v107, v107
    v_exp_f32 v108, v108
    v_exp_f32 v109, v109
    v_mfma_f32_32x32x8_bf16 v[116:131], v[48:49], v[38:39], v[116:131]
    v_exp_f32 v110, v110
    v_exp_f32 v111, v111
    v_exp_f32 v112, v112
    v_exp_f32 v113, v113
    v_smfmac_f32_32x32x32_bf16 v[68:83], v[52:55], v[100:107], v8
    s_waitcnt lgkmcnt(2)
    v_exp_f32 v114, v114
    v_exp_f32 v115, v115
    v_exp_f32 v116, v116
    v_exp_f32 v117, v117
    v_smfmac_f32_32x32x32_bf16 v[68:83], v[60:63], v[108:115], v8
    s_waitcnt lgkmcnt(0)
    s_barrier
    ds_read_b128 v[40:43], v9 offset:0
    ds_read_b64 v[48:49], v10 offset:0
    v_exp_f32 v118, v118
    v_exp_f32 v119, v119
    v_exp_f32 v120, v120
    v_exp_f32 v121, v121
    v_mfma_f32_32x32x16_bf16 v[100:115], v[44:47], v[28:31], 0
    v_exp_f32 v122, v122
    v_exp_f32 v123, v123
    v_exp_f32 v124, v124
    v_exp_f32 v125, v125
    v_mfma_f32_32x32x8_bf16 v[100:115], v[50:51], v[36:37], v[100:115]
    v_exp_f32 v126, v126
    v_exp_f32 v127, v127
    v_exp_f32 v128, v128
    v_exp_f32 v129, v129
    v_smfmac_f32_32x32x32_bf16 v[84:99], v[52:55], v[116:123], v8
    s_waitcnt lgkmcnt(2)
    v_exp_f32 v130, v130
    v_exp_f32 v131, v131
    s_setprio 3
    v_exp_f32 v100, v100
    v_exp_f32 v101, v101
    v_smfmac_f32_32x32x32_bf16 v[84:99], v[60:63], v[124:131], v8
    ds_read_b128 v[52:55], v11 offset:0
    ds_read_b128 v[60:63], v11 offset:640
    v_exp_f32 v102, v102
    v_exp_f32 v103, v103
    v_exp_f32 v104, v104
    v_exp_f32 v105, v105
    v_mfma_f32_32x32x16_bf16 v[116:131], v[44:47], v[32:35], 0
    v_exp_f32 v106, v106
    v_exp_f32 v107, v107
    v_exp_f32 v108, v108
    v_exp_f32 v109, v109
    v_mfma_f32_32x32x8_bf16 v[116:131], v[50:51], v[38:39], v[116:131]
    v_exp_f32 v110, v110
    v_exp_f32 v111, v111
    v_exp_f32 v112, v112
    v_exp_f32 v113, v113
    v_smfmac_f32_32x32x32_bf16 v[68:83], v[56:59], v[100:107], v8
    s_waitcnt lgkmcnt(2)
    v_exp_f32 v114, v114
    v_exp_f32 v115, v115
    s_setprio 2
    v_exp_f32 v116, v116
    v_exp_f32 v117, v117
    v_smfmac_f32_32x32x32_bf16 v[68:83], v[64:67], v[108:115], v8
    ds_read_b128 v[44:47], v9 offset:2560
    ds_read_b64 v[50:51], v10 offset:2560
    v_exp_f32 v118, v118
    v_exp_f32 v119, v119
    v_exp_f32 v120, v120
    v_exp_f32 v121, v121
    v_mfma_f32_32x32x16_bf16 v[100:115], v[40:43], v[28:31], 0
    v_exp_f32 v122, v122
    v_exp_f32 v123, v123
    v_exp_f32 v124, v124
    v_exp_f32 v125, v125
    v_mfma_f32_32x32x8_bf16 v[100:115], v[48:49], v[36:37], v[100:115]
    v_exp_f32 v126, v126
    v_exp_f32 v127, v127
    v_exp_f32 v128, v128
    v_exp_f32 v129, v129
    v_smfmac_f32_32x32x32_bf16 v[84:99], v[56:59], v[116:123], v8
    s_waitcnt lgkmcnt(2)
    v_exp_f32 v130, v130
    v_exp_f32 v131, v131
    s_cmp_eq_u32 s44, 15
    s_cbranch_scc1 concat_heads__mha_block__mha_block__prompt_kernel_lend
    s_setprio 3
    v_exp_f32 v100, v100
    v_exp_f32 v101, v101
    v_smfmac_f32_32x32x32_bf16 v[84:99], v[64:67], v[124:131], v8
    ds_read_b128 v[56:59], v11 offset:2560
    ds_read_b128 v[64:67], v11 offset:3200
    v_exp_f32 v102, v102
    v_exp_f32 v103, v103
    v_exp_f32 v104, v104
    v_exp_f32 v105, v105
    v_mfma_f32_32x32x16_bf16 v[116:131], v[40:43], v[32:35], 0
    v_exp_f32 v106, v106
    v_exp_f32 v107, v107
    v_exp_f32 v108, v108
    v_exp_f32 v109, v109
    v_mfma_f32_32x32x8_bf16 v[116:131], v[48:49], v[38:39], v[116:131]
    v_exp_f32 v110, v110
    v_exp_f32 v111, v111
    v_exp_f32 v112, v112
    v_exp_f32 v113, v113
    v_smfmac_f32_32x32x32_bf16 v[68:83], v[52:55], v[100:107], v8
    s_waitcnt lgkmcnt(2)
    v_exp_f32 v114, v114
    v_exp_f32 v115, v115
    s_setprio 2
    v_exp_f32 v116, v116
    v_exp_f32 v117, v117
    v_smfmac_f32_32x32x32_bf16 v[68:83], v[60:63], v[108:115], v8
    ds_read_b128 v[40:43], v9 offset:5120
    ds_read_b64 v[48:49], v10 offset:5120
    v_exp_f32 v118, v118
    v_exp_f32 v119, v119
    v_exp_f32 v120, v120
    v_exp_f32 v121, v121
    v_mfma_f32_32x32x16_bf16 v[100:115], v[44:47], v[28:31], 0
    v_exp_f32 v122, v122
    v_exp_f32 v123, v123
    v_exp_f32 v124, v124
    v_exp_f32 v125, v125
    v_mfma_f32_32x32x8_bf16 v[100:115], v[50:51], v[36:37], v[100:115]
    v_exp_f32 v126, v126
    v_exp_f32 v127, v127
    v_exp_f32 v128, v128
    v_exp_f32 v129, v129
    v_smfmac_f32_32x32x32_bf16 v[84:99], v[52:55], v[116:123], v8
    s_waitcnt lgkmcnt(2)
    v_exp_f32 v130, v130
    v_exp_f32 v131, v131
    s_setprio 1
    v_exp_f32 v100, v100
    v_exp_f32 v101, v101
    v_smfmac_f32_32x32x32_bf16 v[84:99], v[60:63], v[124:131], v8
    ds_read_b128 v[52:55], v11 offset:5120
    ds_read_b128 v[60:63], v11 offset:5760
    v_exp_f32 v102, v102
    v_exp_f32 v103, v103
    v_exp_f32 v104, v104
    v_exp_f32 v105, v105
    v_mfma_f32_32x32x16_bf16 v[116:131], v[44:47], v[32:35], 0
    v_exp_f32 v106, v106
    v_exp_f32 v107, v107
    v_exp_f32 v108, v108
    v_exp_f32 v109, v109
    v_mfma_f32_32x32x8_bf16 v[116:131], v[50:51], v[38:39], v[116:131]
    v_exp_f32 v110, v110
    v_exp_f32 v111, v111
    v_exp_f32 v112, v112
    v_exp_f32 v113, v113
    v_smfmac_f32_32x32x32_bf16 v[68:83], v[56:59], v[100:107], v8
    s_waitcnt lgkmcnt(2)
    v_exp_f32 v114, v114
    v_exp_f32 v115, v115
    v_exp_f32 v116, v116
    v_exp_f32 v117, v117
    v_smfmac_f32_32x32x32_bf16 v[68:83], v[64:67], v[108:115], v8
    ds_read_b128 v[44:47], v9 offset:7680
    ds_read_b64 v[50:51], v10 offset:7680
    v_exp_f32 v118, v118
    v_exp_f32 v119, v119
    v_exp_f32 v120, v120
    v_exp_f32 v121, v121
    v_mfma_f32_32x32x16_bf16 v[100:115], v[40:43], v[28:31], 0
    v_exp_f32 v122, v122
    v_exp_f32 v123, v123
    v_exp_f32 v124, v124
    v_exp_f32 v125, v125
    v_mfma_f32_32x32x8_bf16 v[100:115], v[48:49], v[36:37], v[100:115]
    v_exp_f32 v126, v126
    v_exp_f32 v127, v127
    v_exp_f32 v128, v128
    v_exp_f32 v129, v129
    v_smfmac_f32_32x32x32_bf16 v[84:99], v[56:59], v[116:123], v8
    s_waitcnt lgkmcnt(2)
    v_exp_f32 v130, v130
    v_exp_f32 v131, v131
    s_setprio 0
    v_exp_f32 v100, v100
    v_exp_f32 v101, v101
    v_smfmac_f32_32x32x32_bf16 v[84:99], v[64:67], v[124:131], v8
    ds_read_b128 v[56:59], v11 offset:7680
    ds_read_b128 v[64:67], v11 offset:8320
    v_exp_f32 v102, v102
    v_exp_f32 v103, v103
    v_exp_f32 v104, v104
    v_exp_f32 v105, v105
    v_mfma_f32_32x32x16_bf16 v[116:131], v[40:43], v[32:35], 0
    v_exp_f32 v106, v106
    v_exp_f32 v107, v107
    v_exp_f32 v108, v108
    v_exp_f32 v109, v109
    v_mfma_f32_32x32x8_bf16 v[116:131], v[48:49], v[38:39], v[116:131]
    v_exp_f32 v110, v110
    v_exp_f32 v111, v111
    v_exp_f32 v112, v112
    v_exp_f32 v113, v113
    v_smfmac_f32_32x32x32_bf16 v[68:83], v[52:55], v[100:107], v8
    s_waitcnt lgkmcnt(2)
    v_exp_f32 v114, v114
    v_exp_f32 v115, v115
    v_exp_f32 v116, v116
    v_exp_f32 v117, v117
    v_smfmac_f32_32x32x32_bf16 v[68:83], v[60:63], v[108:115], v8
    s_waitcnt lgkmcnt(0)
    s_barrier
    ds_read_b128 v[40:43], v132 offset:0
    ds_read_b64 v[48:49], v133 offset:0
    v_exp_f32 v118, v118
    v_exp_f32 v119, v119
    v_exp_f32 v120, v120
    v_exp_f32 v121, v121
    v_mfma_f32_32x32x16_bf16 v[100:115], v[44:47], v[28:31], 0
    v_exp_f32 v122, v122
    v_exp_f32 v123, v123
    v_exp_f32 v124, v124
    v_exp_f32 v125, v125
    v_mfma_f32_32x32x8_bf16 v[100:115], v[50:51], v[36:37], v[100:115]
    v_exp_f32 v126, v126
    v_exp_f32 v127, v127
    v_exp_f32 v128, v128
    v_exp_f32 v129, v129
    v_smfmac_f32_32x32x32_bf16 v[84:99], v[52:55], v[116:123], v8
    s_waitcnt lgkmcnt(2)
    v_exp_f32 v130, v130
    v_exp_f32 v131, v131
    s_setprio 3
    v_exp_f32 v100, v100
    v_exp_f32 v101, v101
    v_smfmac_f32_32x32x32_bf16 v[84:99], v[60:63], v[124:131], v8
    ds_read_b128 v[52:55], v134 offset:0
    ds_read_b128 v[60:63], v134 offset:640
    v_exp_f32 v102, v102
    v_exp_f32 v103, v103
    v_exp_f32 v104, v104
    v_exp_f32 v105, v105
    v_mfma_f32_32x32x16_bf16 v[116:131], v[44:47], v[32:35], 0
    v_exp_f32 v106, v106
    v_exp_f32 v107, v107
    v_exp_f32 v108, v108
    v_exp_f32 v109, v109
    v_mfma_f32_32x32x8_bf16 v[116:131], v[50:51], v[38:39], v[116:131]
    v_exp_f32 v110, v110
    v_exp_f32 v111, v111
    v_exp_f32 v112, v112
    v_exp_f32 v113, v113
    v_smfmac_f32_32x32x32_bf16 v[68:83], v[56:59], v[100:107], v8
    s_waitcnt lgkmcnt(2)
    v_exp_f32 v114, v114
    v_exp_f32 v115, v115
    s_setprio 2
    v_exp_f32 v116, v116
    v_exp_f32 v117, v117
    v_smfmac_f32_32x32x32_bf16 v[68:83], v[64:67], v[108:115], v8
    ds_read_b128 v[44:47], v132 offset:2560
    ds_read_b64 v[50:51], v133 offset:2560
    v_exp_f32 v118, v118
    v_exp_f32 v119, v119
    v_exp_f32 v120, v120
    v_exp_f32 v121, v121
    v_mfma_f32_32x32x16_bf16 v[100:115], v[40:43], v[28:31], 0
    v_exp_f32 v122, v122
    v_exp_f32 v123, v123
    v_exp_f32 v124, v124
    v_exp_f32 v125, v125
    v_mfma_f32_32x32x8_bf16 v[100:115], v[48:49], v[36:37], v[100:115]
    v_exp_f32 v126, v126
    v_exp_f32 v127, v127
    v_exp_f32 v128, v128
    v_exp_f32 v129, v129
    v_smfmac_f32_32x32x32_bf16 v[84:99], v[56:59], v[116:123], v8
    s_waitcnt lgkmcnt(2)
    v_exp_f32 v130, v130
    v_exp_f32 v131, v131
    s_setprio 3
    v_exp_f32 v100, v100
    v_exp_f32 v101, v101
    v_smfmac_f32_32x32x32_bf16 v[84:99], v[64:67], v[124:131], v8
    ds_read_b128 v[56:59], v134 offset:2560
    ds_read_b128 v[64:67], v134 offset:3200
    v_exp_f32 v102, v102
    v_exp_f32 v103, v103
    v_exp_f32 v104, v104
    v_exp_f32 v105, v105
    v_mfma_f32_32x32x16_bf16 v[116:131], v[40:43], v[32:35], 0
    v_exp_f32 v106, v106
    v_exp_f32 v107, v107
    v_exp_f32 v108, v108
    v_exp_f32 v109, v109
    v_mfma_f32_32x32x8_bf16 v[116:131], v[48:49], v[38:39], v[116:131]
    v_exp_f32 v110, v110
    v_exp_f32 v111, v111
    v_exp_f32 v112, v112
    v_exp_f32 v113, v113
    v_smfmac_f32_32x32x32_bf16 v[68:83], v[52:55], v[100:107], v8
    s_waitcnt lgkmcnt(2)
    v_exp_f32 v114, v114
    v_exp_f32 v115, v115
    s_setprio 2
    v_exp_f32 v116, v116
    v_exp_f32 v117, v117
    v_smfmac_f32_32x32x32_bf16 v[68:83], v[60:63], v[108:115], v8
    ds_read_b128 v[40:43], v132 offset:5120
    ds_read_b64 v[48:49], v133 offset:5120
    v_exp_f32 v118, v118
    v_exp_f32 v119, v119
    v_exp_f32 v120, v120
    v_exp_f32 v121, v121
    v_mfma_f32_32x32x16_bf16 v[100:115], v[44:47], v[28:31], 0
    v_exp_f32 v122, v122
    v_exp_f32 v123, v123
    v_exp_f32 v124, v124
    v_exp_f32 v125, v125
    v_mfma_f32_32x32x8_bf16 v[100:115], v[50:51], v[36:37], v[100:115]
    v_exp_f32 v126, v126
    v_exp_f32 v127, v127
    v_exp_f32 v128, v128
    v_exp_f32 v129, v129
    v_smfmac_f32_32x32x32_bf16 v[84:99], v[52:55], v[116:123], v8
    s_waitcnt lgkmcnt(2)
    v_exp_f32 v130, v130
    v_exp_f32 v131, v131
    s_setprio 1
    v_exp_f32 v100, v100
    v_exp_f32 v101, v101
    v_smfmac_f32_32x32x32_bf16 v[84:99], v[60:63], v[124:131], v8
    ds_read_b128 v[52:55], v134 offset:5120
    ds_read_b128 v[60:63], v134 offset:5760
    v_exp_f32 v102, v102
    v_exp_f32 v103, v103
    v_exp_f32 v104, v104
    v_exp_f32 v105, v105
    v_mfma_f32_32x32x16_bf16 v[116:131], v[44:47], v[32:35], 0
    v_exp_f32 v106, v106
    v_exp_f32 v107, v107
    v_exp_f32 v108, v108
    v_exp_f32 v109, v109
    v_mfma_f32_32x32x8_bf16 v[116:131], v[50:51], v[38:39], v[116:131]
    v_exp_f32 v110, v110
    v_exp_f32 v111, v111
    v_exp_f32 v112, v112
    v_exp_f32 v113, v113
    v_smfmac_f32_32x32x32_bf16 v[68:83], v[56:59], v[100:107], v8
    s_waitcnt lgkmcnt(2)
    v_exp_f32 v114, v114
    v_exp_f32 v115, v115
    v_exp_f32 v116, v116
    v_exp_f32 v117, v117
    v_smfmac_f32_32x32x32_bf16 v[68:83], v[64:67], v[108:115], v8
    ds_read_b128 v[44:47], v132 offset:7680
    ds_read_b64 v[50:51], v133 offset:7680
    v_exp_f32 v118, v118
    v_exp_f32 v119, v119
    v_exp_f32 v120, v120
    v_exp_f32 v121, v121
    v_mfma_f32_32x32x16_bf16 v[100:115], v[40:43], v[28:31], 0
    v_exp_f32 v122, v122
    v_exp_f32 v123, v123
    v_exp_f32 v124, v124
    v_exp_f32 v125, v125
    v_mfma_f32_32x32x8_bf16 v[100:115], v[48:49], v[36:37], v[100:115]
    v_exp_f32 v126, v126
    v_exp_f32 v127, v127
    v_exp_f32 v128, v128
    v_exp_f32 v129, v129
    v_smfmac_f32_32x32x32_bf16 v[84:99], v[56:59], v[116:123], v8
    s_waitcnt lgkmcnt(2)
    v_exp_f32 v130, v130
    v_exp_f32 v131, v131
    s_setprio 0
    v_exp_f32 v100, v100
    v_exp_f32 v101, v101
    v_smfmac_f32_32x32x32_bf16 v[84:99], v[64:67], v[124:131], v8
    ds_read_b128 v[56:59], v134 offset:7680
    ds_read_b128 v[64:67], v134 offset:8320
    v_exp_f32 v102, v102
    v_exp_f32 v103, v103
    v_exp_f32 v104, v104
    v_exp_f32 v105, v105
    v_mfma_f32_32x32x16_bf16 v[116:131], v[40:43], v[32:35], 0
    v_exp_f32 v106, v106
    v_exp_f32 v107, v107
    v_exp_f32 v108, v108
    v_exp_f32 v109, v109
    v_mfma_f32_32x32x8_bf16 v[116:131], v[48:49], v[38:39], v[116:131]
    v_exp_f32 v110, v110
    v_exp_f32 v111, v111
    v_exp_f32 v112, v112
    v_exp_f32 v113, v113
    v_smfmac_f32_32x32x32_bf16 v[68:83], v[52:55], v[100:107], v8
    s_waitcnt lgkmcnt(2)
    v_exp_f32 v114, v114
    v_exp_f32 v115, v115
    v_exp_f32 v116, v116
    v_exp_f32 v117, v117
    v_smfmac_f32_32x32x32_bf16 v[68:83], v[60:63], v[108:115], v8
    s_waitcnt lgkmcnt(0)
    s_barrier
    ds_read_b128 v[40:43], v12 offset:0
    ds_read_b64 v[48:49], v13 offset:0
    v_exp_f32 v118, v118
    v_exp_f32 v119, v119
    v_exp_f32 v120, v120
    v_exp_f32 v121, v121
    v_mfma_f32_32x32x16_bf16 v[100:115], v[44:47], v[28:31], 0
    v_exp_f32 v122, v122
    v_exp_f32 v123, v123
    v_exp_f32 v124, v124
    v_exp_f32 v125, v125
    v_mfma_f32_32x32x8_bf16 v[100:115], v[50:51], v[36:37], v[100:115]
    v_exp_f32 v126, v126
    v_exp_f32 v127, v127
    v_exp_f32 v128, v128
    v_exp_f32 v129, v129
    v_smfmac_f32_32x32x32_bf16 v[84:99], v[52:55], v[116:123], v8
    s_waitcnt lgkmcnt(2)
    v_exp_f32 v130, v130
    v_exp_f32 v131, v131
    s_setprio 3
    v_exp_f32 v100, v100
    v_exp_f32 v101, v101
    v_smfmac_f32_32x32x32_bf16 v[84:99], v[60:63], v[124:131], v8
    ds_read_b128 v[52:55], v14 offset:0
    ds_read_b128 v[60:63], v14 offset:640
    v_exp_f32 v102, v102
    v_exp_f32 v103, v103
    v_exp_f32 v104, v104
    v_exp_f32 v105, v105
    v_mfma_f32_32x32x16_bf16 v[116:131], v[44:47], v[32:35], 0
    v_exp_f32 v106, v106
    v_exp_f32 v107, v107
    v_exp_f32 v108, v108
    v_exp_f32 v109, v109
    v_mfma_f32_32x32x8_bf16 v[116:131], v[50:51], v[38:39], v[116:131]
    v_exp_f32 v110, v110
    v_exp_f32 v111, v111
    v_exp_f32 v112, v112
    v_exp_f32 v113, v113
    v_smfmac_f32_32x32x32_bf16 v[68:83], v[56:59], v[100:107], v8
    s_waitcnt lgkmcnt(2)
    v_exp_f32 v114, v114
    v_exp_f32 v115, v115
    s_setprio 2
    v_exp_f32 v116, v116
    v_exp_f32 v117, v117
    v_smfmac_f32_32x32x32_bf16 v[68:83], v[64:67], v[108:115], v8
    ds_read_b128 v[44:47], v12 offset:2560
    ds_read_b64 v[50:51], v13 offset:2560
    v_exp_f32 v118, v118
    v_exp_f32 v119, v119
    v_exp_f32 v120, v120
    v_exp_f32 v121, v121
    v_mfma_f32_32x32x16_bf16 v[100:115], v[40:43], v[28:31], 0
    v_exp_f32 v122, v122
    v_exp_f32 v123, v123
    v_exp_f32 v124, v124
    v_exp_f32 v125, v125
    v_mfma_f32_32x32x8_bf16 v[100:115], v[48:49], v[36:37], v[100:115]
    v_exp_f32 v126, v126
    v_exp_f32 v127, v127
    v_exp_f32 v128, v128
    v_exp_f32 v129, v129
    v_smfmac_f32_32x32x32_bf16 v[84:99], v[56:59], v[116:123], v8
    s_waitcnt lgkmcnt(2)
    v_exp_f32 v130, v130
    v_exp_f32 v131, v131
    s_add_u32 s44, s44, 3
    s_cmp_lt_u32 s44, 16
    s_cbranch_scc1 concat_heads__mha_block__mha_block__prompt_kernel_loop
concat_heads__mha_block__mha_block__prompt_kernel_lend:
    s_nop 1
    v_smfmac_f32_32x32x32_bf16 v[84:99], v[64:67], v[124:131], v8
    s_setprio 0
    s_waitcnt lgkmcnt(0)
    s_mov_b32 s55, 0
concat_heads__mha_block__mha_block__prompt_kernel_store:
    s_mov_b32 s48, 0xaaaaaaaa
    s_mov_b32 s49, 0xaaaaaaaa
    v_mov_b32 v2, v76
    v_mov_b32 v4, v2
    s_nop 1
    v_permlane32_swap_b32 v2, v4
    s_nop 1
    v_rcp_f32 v2, v4
    s_nop 0
    v_mul_f32 v68, v68, v2
    v_mul_f32 v69, v69, v2
    v_mul_f32 v70, v70, v2
    v_mul_f32 v71, v71, v2
    v_mul_f32 v72, v72, v2
    v_mul_f32 v73, v73, v2
    v_mul_f32 v74, v74, v2
    v_mul_f32 v75, v75, v2
    v_mul_f32 v76, v76, v2
    v_mul_f32 v77, v77, v2
    v_mul_f32 v78, v78, v2
    v_mul_f32 v79, v79, v2
    v_cvt_pk_bf16_f32 v100, v68, v69
    v_cvt_pk_bf16_f32 v101, v70, v71
    v_cvt_pk_bf16_f32 v102, v72, v73
    v_cvt_pk_bf16_f32 v103, v74, v75
    buffer_store_dwordx4 v[100:103], v17, s[16:19], s46 offen offset:0 sc1
    v_cvt_pk_bf16_f32 v104, v76, v77
    v_cvt_pk_bf16_f32 v105, v78, v79
    v_mov_b32 v2, v92
    v_mov_b32 v5, v2
    s_nop 1
    v_permlane32_swap_b32 v2, v5
    s_nop 1
    v_rcp_f32 v2, v5
    s_nop 0
    v_mul_f32 v84, v84, v2
    v_mul_f32 v85, v85, v2
    v_mul_f32 v86, v86, v2
    v_mul_f32 v87, v87, v2
    v_mul_f32 v88, v88, v2
    v_mul_f32 v89, v89, v2
    v_mul_f32 v90, v90, v2
    v_mul_f32 v91, v91, v2
    v_mul_f32 v92, v92, v2
    v_mul_f32 v93, v93, v2
    v_mul_f32 v94, v94, v2
    v_mul_f32 v95, v95, v2
    v_cvt_pk_bf16_f32 v116, v84, v85
    v_cvt_pk_bf16_f32 v117, v86, v87
    v_cvt_pk_bf16_f32 v118, v88, v89
    v_cvt_pk_bf16_f32 v119, v90, v91
    buffer_store_dwordx4 v[116:119], v17, s[16:19], s46 offen offset:1024 sc1
    v_cvt_pk_bf16_f32 v106, v92, v93
    v_cvt_pk_bf16_f32 v107, v94, v95
    v_cndmask_b32_e64 v108, v106, v104, s[48:49]
    v_cndmask_b32_e64 v109, v107, v105, s[48:49]
    v_lshrrev_b32 v2, 1, v1
    v_and_b32 v3, 1, v1
    v_mov_b32_dpp v110, v108 quad_perm:[1,0,3,2] row_mask:0xf bank_mask:0xf
    v_mov_b32_dpp v111, v109 quad_perm:[1,0,3,2] row_mask:0xf bank_mask:0xf
    v_lshlrev_b32 v2, 4, v2
    v_lshl_add_u32 v2, v3, 8, v2
    v_mov_b32 v3, 1073741824
    v_cndmask_b32_e64 v112, v104, v110, s[48:49]
    v_cndmask_b32_e64 v113, v105, v111, s[48:49]
    v_cndmask_b32_e64 v114, v110, v106, s[48:49]
    v_cndmask_b32_e64 v115, v111, v107, s[48:49]
    v_cndmask_b32_e64 v2, v2, v3, s[42:43]
    buffer_store_dwordx4 v[112:115], v2, s[16:19], s46 offen offset:2048 sc1
    v_mul_f32 v3, 0, v68
    v_fmac_f32 v3, 0, v69
    v_fmac_f32 v3, 0, v70
    v_fmac_f32 v3, 0, v71
    v_fmac_f32 v3, 0, v72
    v_fmac_f32 v3, 0, v73
    v_fmac_f32 v3, 0, v74
    v_fmac_f32 v3, 0, v75
    v_fmac_f32 v3, 0, v76
    v_fmac_f32 v3, 0, v77
    v_fmac_f32 v3, 0, v78
    v_fmac_f32 v3, 0, v79
    v_add_f32 v3, v3, v4
    v_cmp_gt_f32 vcc, 0x53800000, v3
    s_mov_b64 s[48:49], vcc
    v_cmp_lt_f32 vcc, 0x35800000, v3
    s_and_b64 s[48:49], s[48:49], vcc
    v_mul_f32 v3, 0, v84
    v_fmac_f32 v3, 0, v85
    v_fmac_f32 v3, 0, v86
    v_fmac_f32 v3, 0, v87
    v_fmac_f32 v3, 0, v88
    v_fmac_f32 v3, 0, v89
    v_fmac_f32 v3, 0, v90
    v_fmac_f32 v3, 0, v91
    v_fmac_f32 v3, 0, v92
    v_fmac_f32 v3, 0, v93
    v_fmac_f32 v3, 0, v94
    v_fmac_f32 v3, 0, v95
    v_add_f32 v3, v3, v5
    v_cmp_gt_f32 vcc, 0x53800000, v3
    s_mov_b64 s[50:51], vcc
    v_cmp_lt_f32 vcc, 0x35800000, v3
    s_and_b64 s[50:51], s[50:51], vcc
    s_and_b64 s[48:49], s[48:49], s[50:51]
    s_cmp_eq_u64 s[48:49], -1
    s_cselect_b32 s36, 1, s55
    s_cmp_eq_u32 s36, 0
    s_cbranch_scc1 concat_heads__mha_block__mha_block__prompt_kernel_fallback
    s_lshl_b32 s36, s33, 4
    s_add_u32 s36, s36, s4
    s_lshl_b32 s36, s36, 1
    s_lshr_b32 s37, s32, 2
    s_add_u32 s36, s36, s37
    s_mul_i32 s60, s36, 81920
    s_add_u32 s60, s60, 10485760
    s_and_b32 s36, s32, 1
    s_lshl_b32 s36, s36, 4
    s_bfe_u32 s37, s32, 0x10001
    v_and_b32 v2, 15, v1
    v_add_u32 v2, s36, v2
    v_lshlrev_b32 v2, 4, v2
    v_lshrrev_b32 v3, 5, v1
    v_mul_u32_u24 v3, 2560, v3
    v_bfe_u32 v4, v1, 4, 1
    v_lshl_add_u32 v3, v4, 9, v3
    s_lshl_b32 s38, s37, 10
    v_add3_u32 v164, v2, v3, s38
    v_lshrrev_b32 v3, 4, v1
    v_mul_u32_u24 v3, 2560, v3
    s_lshl_b32 s38, s37, 8
    s_add_u32 s38, s38, 2048
    v_lshrrev_b32 v2, 1, v2
    v_add3_u32 v165, v2, v3, s38
    s_and_b32 s39, s5, 3
    s_lshl_b32 s39, s39, 1
    s_mov_b32 s40, -1
    s_mov_b32 s41, 0
    v_bfe_u32 v2, v1, 2, 2
    v_lshrrev_b32 v3, 5, v1
    v_mul_u32_u24 v3, 20, v3
    v_bfe_u32 v4, v1, 4, 1
    v_lshl_add_u32 v3, v4, 2, v3
    v_add_u32 v3, v3, v2
    v_mul_u32_u24 v3, 160, v3
    v_and_b32 v4, 3, v1
    v_lshl_add_u32 v8, v4, 3, v3
    v_lshrrev_b32 v3, 4, v1
    v_mul_u32_u24 v3, 20, v3
    v_add3_u32 v3, v3, v2, 16
    v_mul_u32_u24 v3, 160, v3
    v_lshl_add_u32 v9, v4, 3, v3
    s_lshl_b32 s36, s4, 7
    s_lshl_b32 s37, s32, 4
    s_add_u32 s36, s36, s37
    v_and_b32 v2, 15, v1
    v_add_u32 v2, s36, v2
    v_mul_u32_u24 v2, 2560, v2
    v_lshrrev_b32 v3, 4, v1
    v_lshl_add_u32 v2, v3, 3, v2
    s_mul_i32 s36, s33, 1280
    s_mul_i32 s37, s5, 160
    s_add_u32 s36, s36, s37
    v_add_u32 v12, s36, v2
    v_mov_b32 v10, 122880
    s_lshl_b32 s37, s4, 3
    s_add_u32 s37, s37, s32
    s_mul_i32 s37, s37, 40960
    s_add_u32 s46, s36, s37
    s_mul_i32 s37, s32, 3072
    v_and_b32 v2, 15, v1
    v_mul_u32_u24 v2, 160, v2
    v_lshl_add_u32 v2, v3, 3, v2
    v_add_u32 v166, s37, v2
    v_lshlrev_b32 v2, 4, v1
    v_add_u32 v167, s37, v2
    v_mul_u32_u24 v3, 6554, v1
    v_lshrrev_b32 v3, 16, v3
    v_mul_u32_u24 v3, 2400, v3
    v_add_u32 v12, v2, v3
    v_add_u32 v4, 64, v1
    v_mul_u32_u24 v3, 6554, v4
    v_lshrrev_b32 v3, 16, v3
    v_mul_u32_u24 v3, 2400, v3
    v_lshl_add_u32 v13, v4, 4, v3
    v_add_u32 v4, 128, v1
    v_mul_u32_u24 v3, 6554, v4
    v_lshrrev_b32 v3, 16, v3
    v_mul_u32_u24 v3, 2400, v3
    v_lshl_add_u32 v3, v4, 4, v3
    v_mov_b32 v4, 1073741824
    v_cndmask_b32_e64 v14, v3, v4, s[42:43]
    s_lshl_b32 s36, s33, 4
    s_add_u32 s36, s36, s34
    s_lshl_b32 s36, s36, 6
    s_add_u32 s36, s36, s35
    s_lshl_b32 s36, s36, 2
    s_add_u32 s36, s36, 15732736
    v_mov_b32 v11, s36
    v_add_u32 v8, 40960, v8
    v_add_u32 v9, 40960, v9
    v_mov_b32 v24, 0
    v_mov_b32 v25, 0
    v_mov_b32 v26, 0
    v_mov_b32 v27, 0
    v_mov_b32 v28, 0
    v_mov_b32 v29, 0
    v_mov_b32 v30, 0
    v_mov_b32 v31, 0
    v_mov_b32 v32, 0
    v_mov_b32 v33, 0
    v_mov_b32 v34, 0
    v_mov_b32 v35, 0
    v_mov_b32 v36, 0
    v_mov_b32 v37, 0
    v_mov_b32 v38, 0
    v_mov_b32 v39, 0
    v_mov_b32 v40, 0
    v_mov_b32 v41, 0
    v_mov_b32 v42, 0
    v_mov_b32 v43, 0
    s_waitcnt vmcnt(0)
    s_mov_b64 exec, 1
    v_mov_b32 v2, 1
    ds_add_rtn_u32 v2, v10, v2 offset:8
    v_mov_b32 v3, s61
    v_mov_b32 v4, 0xff
    s_waitcnt lgkmcnt(0)
    v_readfirstlane_b32 s36, v2
    s_cmp_eq_u32 s36, 7
    s_cbranch_scc0 concat_heads__mha_block__mha_block__prompt_kernel_nl
    ds_write_b32 v10, v4 offset:4
    v_mov_b32 v3, s61
    buffer_store_dword v3, v11, s[16:19], 0 offen sc1
concat_heads__mha_block__mha_block__prompt_kernel_nl:
    s_mov_b64 exec, -1
    s_cmp_lg_u32 s40, -1
    s_cselect_b32 s55, 1, 0
    v_add_u32 v15, s40, v8
    v_add_u32 v19, s40, v9
    s_mov_b32 s44, 0
concat_heads__mha_block__mha_block__prompt_kernel_ev:
    s_cmp_lt_u32 s55, 4
    s_cbranch_scc0 concat_heads__mha_block__mha_block__prompt_kernel_evc
    s_sub_u32 s36, s55, s44
    s_cmp_ge_u32 s36, 2
    s_cbranch_scc1 concat_heads__mha_block__mha_block__prompt_kernel_evc
    ds_read_b64 v[2:3], v10
    s_waitcnt lgkmcnt(0)
    v_and_b32 v2, v2, v3
    s_nop 0
    v_readfirstlane_b32 s36, v2
    s_andn2_b32 s36, s36, s41
    s_cbranch_scc0 concat_heads__mha_block__mha_block__prompt_kernel_evn
    s_cmp_eq_u32 s55, 0
    s_cbranch_scc0 concat_heads__mha_block__mha_block__prompt_kernel_evt0
    s_setprio 3
    s_lshl_b32 s37, s36, 8
    s_or_b32 s36, s36, s37
    s_lshr_b32 s36, s36, s39
    s_ff1_i32_b32 s36, s36
    s_add_u32 s36, s36, s39
    s_and_b32 s36, s36, 7
    s_bitset1_b32 s41, s36
    s_mul_i32 s37, s36, 10240
    s_add_u32 s37, s37, s60
    s_cmp_eq_u32 s36, 6
    s_mul_i32 s36, s36, 12800
    s_cselect_b32 s36, 90624, s36
    buffer_load_dwordx4 v[144:147], v164, s[16:19], s37 offen sc1
    buffer_load_dwordx2 v[160:161], v165, s[16:19], s37 offen sc1
    s_add_u32 s37, s37, 5120
    buffer_load_dwordx4 v[148:151], v164, s[16:19], s37 offen sc1
    s_add_u32 s37, s37, 5120
    buffer_load_dwordx4 v[152:155], v164, s[16:19], s37 offen sc1
    buffer_load_dwordx2 v[162:163], v165, s[16:19], s37 offen sc1
    s_add_u32 s37, s37, 5120
    buffer_load_dwordx4 v[156:159], v164, s[16:19], s37 offen sc1
    v_add_u32 v15, s36, v8
    v_add_u32 v19, s36, v9
    s_mov_b32 s55, 1
    s_branch concat_heads__mha_block__mha_block__prompt_kernel_ev
concat_heads__mha_block__mha_block__prompt_kernel_evt0:
    s_cmp_eq_u32 s55, 1
    s_cbranch_scc0 concat_heads__mha_block__mha_block__prompt_kernel_evt1
    s_setprio 2
    s_lshl_b32 s37, s36, 8
    s_or_b32 s36, s36, s37
    s_lshr_b32 s36, s36, s39
    s_ff1_i32_b32 s36, s36
    s_add_u32 s36, s36, s39
    s_and_b32 s36, s36, 7
    s_bitset1_b32 s41, s36
    s_mul_i32 s37, s36, 10240
    s_add_u32 s37, s37, s60
    s_cmp_eq_u32 s36, 6
    s_mul_i32 s36, s36, 12800
    s_cselect_b32 s36, 90624, s36
    buffer_load_dwordx4 v[84:87], v164, s[16:19], s37 offen sc1
    buffer_load_dwordx2 v[100:101], v165, s[16:19], s37 offen sc1
    s_add_u32 s37, s37, 5120
    buffer_load_dwordx4 v[88:91], v164, s[16:19], s37 offen sc1
    s_add_u32 s37, s37, 5120
    buffer_load_dwordx4 v[92:95], v164, s[16:19], s37 offen sc1
    buffer_load_dwordx2 v[102:103], v165, s[16:19], s37 offen sc1
    s_add_u32 s37, s37, 5120
    buffer_load_dwordx4 v[96:99], v164, s[16:19], s37 offen sc1
    v_add_u32 v16, s36, v8
    v_add_u32 v20, s36, v9
    s_mov_b32 s55, 2
    s_branch concat_heads__mha_block__mha_block__prompt_kernel_ev
concat_heads__mha_block__mha_block__prompt_kernel_evt1:
    s_cmp_eq_u32 s55, 2
    s_cbranch_scc0 concat_heads__mha_block__mha_block__prompt_kernel_evt2
    s_setprio 1
    s_lshl_b32 s37, s36, 8
    s_or_b32 s36, s36, s37
    s_lshr_b32 s36, s36, s39
    s_ff1_i32_b32 s36, s36
    s_add_u32 s36, s36, s39
    s_and_b32 s36, s36, 7
    s_bitset1_b32 s41, s36
    s_mul_i32 s37, s36, 10240
    s_add_u32 s37, s37, s60
    s_cmp_eq_u32 s36, 6
    s_mul_i32 s36, s36, 12800
    s_cselect_b32 s36, 90624, s36
    buffer_load_dwordx4 v[104:107], v164, s[16:19], s37 offen sc1
    buffer_load_dwordx2 v[120:121], v165, s[16:19], s37 offen sc1
    s_add_u32 s37, s37, 5120
    buffer_load_dwordx4 v[108:111], v164, s[16:19], s37 offen sc1
    s_add_u32 s37, s37, 5120
    buffer_load_dwordx4 v[112:115], v164, s[16:19], s37 offen sc1
    buffer_load_dwordx2 v[122:123], v165, s[16:19], s37 offen sc1
    s_add_u32 s37, s37, 5120
    buffer_load_dwordx4 v[116:119], v164, s[16:19], s37 offen sc1
    v_add_u32 v17, s36, v8
    v_add_u32 v21, s36, v9
    s_mov_b32 s55, 3
    s_branch concat_heads__mha_block__mha_block__prompt_kernel_ev
concat_heads__mha_block__mha_block__prompt_kernel_evt2:
    s_setprio 0
    s_lshl_b32 s37, s36, 8
    s_or_b32 s36, s36, s37
    s_lshr_b32 s36, s36, s39
    s_ff1_i32_b32 s36, s36
    s_add_u32 s36, s36, s39
    s_and_b32 s36, s36, 7
    s_bitset1_b32 s41, s36
    s_mul_i32 s37, s36, 10240
    s_add_u32 s37, s37, s60
    s_cmp_eq_u32 s36, 6
    s_mul_i32 s36, s36, 12800
    s_cselect_b32 s36, 90624, s36
    buffer_load_dwordx4 v[124:127], v164, s[16:19], s37 offen sc1
    buffer_load_dwordx2 v[140:141], v165, s[16:19], s37 offen sc1
    s_add_u32 s37, s37, 5120
    buffer_load_dwordx4 v[128:131], v164, s[16:19], s37 offen sc1
    s_add_u32 s37, s37, 5120
    buffer_load_dwordx4 v[132:135], v164, s[16:19], s37 offen sc1
    buffer_load_dwordx2 v[142:143], v165, s[16:19], s37 offen sc1
    s_add_u32 s37, s37, 5120
    buffer_load_dwordx4 v[136:139], v164, s[16:19], s37 offen sc1
    v_add_u32 v18, s36, v8
    v_add_u32 v22, s36, v9
    s_mov_b32 s55, 4
    s_branch concat_heads__mha_block__mha_block__prompt_kernel_ev
concat_heads__mha_block__mha_block__prompt_kernel_evt3:
concat_heads__mha_block__mha_block__prompt_kernel_evn:
    s_getreg_b32 s36, hwreg(HW_REG_IB_STS)
    s_bfe_u32 s37, s36, 0x20016
    s_lshl_b32 s37, s37, 4
    s_and_b32 s36, s36, 15
    s_or_b32 s36, s36, s37
    s_add_u32 s36, s36, 6
    s_sub_u32 s37, s55, s44
    s_mul_i32 s37, s37, 6
    s_cmp_le_u32 s36, s37
    s_cbranch_scc1 concat_heads__mha_block__mha_block__prompt_kernel_evc
    s_branch concat_heads__mha_block__mha_block__prompt_kernel_ev
concat_heads__mha_block__mha_block__prompt_kernel_evc:
    s_cmp_eq_u32 s44, 0
    s_cbranch_scc0 concat_heads__mha_block__mha_block__prompt_kernel_evk0
    ds_read_b64_tr_b16 v[44:45], v15 offset:0
    ds_read_b64_tr_b16 v[46:47], v15 offset:1280
    ds_read_b64_tr_b16 v[48:49], v15 offset:32
    ds_read_b64_tr_b16 v[50:51], v15 offset:1312
    ds_read_b64_tr_b16 v[52:53], v15 offset:64
    ds_read_b64_tr_b16 v[54:55], v15 offset:1344
    ds_read_b64_tr_b16 v[56:57], v15 offset:96
    ds_read_b64_tr_b16 v[58:59], v15 offset:1376
    ds_read_b64_tr_b16 v[60:61], v15 offset:128
    ds_read_b64_tr_b16 v[62:63], v15 offset:1408
    ds_read_b64_tr_b16 v[64:65], v15 offset:6400
    ds_read_b64_tr_b16 v[66:67], v15 offset:7680
    ds_read_b64_tr_b16 v[68:69], v15 offset:6432
    ds_read_b64_tr_b16 v[70:71], v15 offset:7712
    ds_read_b64_tr_b16 v[72:73], v15 offset:6464
    ds_read_b64_tr_b16 v[74:75], v15 offset:7744
    ds_read_b64_tr_b16 v[76:77], v15 offset:6496
    ds_read_b64_tr_b16 v[78:79], v15 offset:7776
    ds_read_b64_tr_b16 v[80:81], v15 offset:6528
    ds_read_b64_tr_b16 v[82:83], v15 offset:7808
    s_cmp_eq_u32 s55, 4
    s_cbranch_scc0 concat_heads__mha_block__mha_block__prompt_kernel_evw0_4
    s_waitcnt vmcnt(18)
    s_branch concat_heads__mha_block__mha_block__prompt_kernel_evx0
concat_heads__mha_block__mha_block__prompt_kernel_evw0_4:
    s_cmp_eq_u32 s55, 3
    s_cbranch_scc0 concat_heads__mha_block__mha_block__prompt_kernel_evw0_3
    s_waitcnt vmcnt(12)
    s_branch concat_heads__mha_block__mha_block__prompt_kernel_evx0
concat_heads__mha_block__mha_block__prompt_kernel_evw0_3:
    s_cmp_eq_u32 s55, 2
    s_cbranch_scc0 concat_heads__mha_block__mha_block__prompt_kernel_evw0_2
    s_waitcnt vmcnt(6)
    s_branch concat_heads__mha_block__mha_block__prompt_kernel_evx0
concat_heads__mha_block__mha_block__prompt_kernel_evw0_2:
    s_waitcnt vmcnt(0)
concat_heads__mha_block__mha_block__prompt_kernel_evx0:
    s_waitcnt lgkmcnt(10)
    v_mfma_f32_16x16x32_bf16 v[24:27], v[44:47], v[144:147], v[24:27]
    ds_read_b64_tr_b16 v[44:45], v15 offset:12800
    ds_read_b64_tr_b16 v[46:47], v15 offset:14080
    v_mfma_f32_16x16x32_bf16 v[28:31], v[48:51], v[144:147], v[28:31]
    ds_read_b64_tr_b16 v[48:49], v15 offset:12832
    ds_read_b64_tr_b16 v[50:51], v15 offset:14112
    v_mfma_f32_16x16x32_bf16 v[32:35], v[52:55], v[144:147], v[32:35]
    ds_read_b64_tr_b16 v[52:53], v15 offset:12864
    ds_read_b64_tr_b16 v[54:55], v15 offset:14144
    v_mfma_f32_16x16x32_bf16 v[36:39], v[56:59], v[144:147], v[36:39]
    ds_read_b64_tr_b16 v[56:57], v15 offset:12896
    ds_read_b64_tr_b16 v[58:59], v15 offset:14176
    v_mfma_f32_16x16x32_bf16 v[40:43], v[60:63], v[144:147], v[40:43]
    ds_read_b64_tr_b16 v[60:61], v15 offset:12928
    ds_read_b64_tr_b16 v[62:63], v15 offset:14208
    s_waitcnt lgkmcnt(10)
    v_mfma_f32_16x16x32_bf16 v[24:27], v[64:67], v[148:151], v[24:27]
    ds_read_b64_tr_b16 v[64:65], v15 offset:19200
    ds_read_b64_tr_b16 v[66:67], v15 offset:20480
    v_mfma_f32_16x16x32_bf16 v[28:31], v[68:71], v[148:151], v[28:31]
    ds_read_b64_tr_b16 v[68:69], v15 offset:19232
    ds_read_b64_tr_b16 v[70:71], v15 offset:20512
    v_mfma_f32_16x16x32_bf16 v[32:35], v[72:75], v[148:151], v[32:35]
    ds_read_b64_tr_b16 v[72:73], v15 offset:19264
    ds_read_b64_tr_b16 v[74:75], v15 offset:20544
    v_mfma_f32_16x16x32_bf16 v[36:39], v[76:79], v[148:151], v[36:39]
    ds_read_b64_tr_b16 v[76:77], v15 offset:19296
    ds_read_b64_tr_b16 v[78:79], v15 offset:20576
    v_mfma_f32_16x16x32_bf16 v[40:43], v[80:83], v[148:151], v[40:43]
    ds_read_b64_tr_b16 v[80:81], v15 offset:19328
    ds_read_b64_tr_b16 v[82:83], v15 offset:20608
    s_waitcnt lgkmcnt(10)
    v_mfma_f32_16x16x32_bf16 v[24:27], v[44:47], v[152:155], v[24:27]
    ds_read_b64_tr_b16 v[44:45], v19 offset:0
    ds_read_b64_tr_b16 v[46:47], v19 offset:12800
    v_mfma_f32_16x16x32_bf16 v[28:31], v[48:51], v[152:155], v[28:31]
    ds_read_b64_tr_b16 v[48:49], v19 offset:32
    ds_read_b64_tr_b16 v[50:51], v19 offset:12832
    v_mfma_f32_16x16x32_bf16 v[32:35], v[52:55], v[152:155], v[32:35]
    ds_read_b64_tr_b16 v[52:53], v19 offset:64
    ds_read_b64_tr_b16 v[54:55], v19 offset:12864
    v_mfma_f32_16x16x32_bf16 v[36:39], v[56:59], v[152:155], v[36:39]
    ds_read_b64_tr_b16 v[56:57], v19 offset:96
    ds_read_b64_tr_b16 v[58:59], v19 offset:12896
    v_mfma_f32_16x16x32_bf16 v[40:43], v[60:63], v[152:155], v[40:43]
    ds_read_b64_tr_b16 v[60:61], v19 offset:128
    ds_read_b64_tr_b16 v[62:63], v19 offset:12928
    s_waitcnt lgkmcnt(10)
    v_mfma_f32_16x16x32_bf16 v[24:27], v[64:67], v[156:159], v[24:27]
    v_mfma_f32_16x16x32_bf16 v[28:31], v[68:71], v[156:159], v[28:31]
    v_mfma_f32_16x16x32_bf16 v[32:35], v[72:75], v[156:159], v[32:35]
    v_mfma_f32_16x16x32_bf16 v[36:39], v[76:79], v[156:159], v[36:39]
    v_mfma_f32_16x16x32_bf16 v[40:43], v[80:83], v[156:159], v[40:43]
    s_waitcnt lgkmcnt(0)
    v_mfma_f32_16x16x32_bf16 v[24:27], v[44:47], v[160:163], v[24:27]
    v_mfma_f32_16x16x32_bf16 v[28:31], v[48:51], v[160:163], v[28:31]
    v_mfma_f32_16x16x32_bf16 v[32:35], v[52:55], v[160:163], v[32:35]
    v_mfma_f32_16x16x32_bf16 v[36:39], v[56:59], v[160:163], v[36:39]
    v_mfma_f32_16x16x32_bf16 v[40:43], v[60:63], v[160:163], v[40:43]
    s_mov_b32 s44, 1
    s_branch concat_heads__mha_block__mha_block__prompt_kernel_ev
concat_heads__mha_block__mha_block__prompt_kernel_evk0:
    s_cmp_eq_u32 s44, 1
    s_cbranch_scc0 concat_heads__mha_block__mha_block__prompt_kernel_evk1
    ds_read_b64_tr_b16 v[44:45], v16 offset:0
    ds_read_b64_tr_b16 v[46:47], v16 offset:1280
    ds_read_b64_tr_b16 v[48:49], v16 offset:32
    ds_read_b64_tr_b16 v[50:51], v16 offset:1312
    ds_read_b64_tr_b16 v[52:53], v16 offset:64
    ds_read_b64_tr_b16 v[54:55], v16 offset:1344
    ds_read_b64_tr_b16 v[56:57], v16 offset:96
    ds_read_b64_tr_b16 v[58:59], v16 offset:1376
    ds_read_b64_tr_b16 v[60:61], v16 offset:128
    ds_read_b64_tr_b16 v[62:63], v16 offset:1408
    ds_read_b64_tr_b16 v[64:65], v16 offset:6400
    ds_read_b64_tr_b16 v[66:67], v16 offset:7680
    ds_read_b64_tr_b16 v[68:69], v16 offset:6432
    ds_read_b64_tr_b16 v[70:71], v16 offset:7712
    ds_read_b64_tr_b16 v[72:73], v16 offset:6464
    ds_read_b64_tr_b16 v[74:75], v16 offset:7744
    ds_read_b64_tr_b16 v[76:77], v16 offset:6496
    ds_read_b64_tr_b16 v[78:79], v16 offset:7776
    ds_read_b64_tr_b16 v[80:81], v16 offset:6528
    ds_read_b64_tr_b16 v[82:83], v16 offset:7808
    s_cmp_eq_u32 s55, 4
    s_cbranch_scc0 concat_heads__mha_block__mha_block__prompt_kernel_evw1_4
    s_waitcnt vmcnt(12)
    s_branch concat_heads__mha_block__mha_block__prompt_kernel_evx1
concat_heads__mha_block__mha_block__prompt_kernel_evw1_4:
    s_cmp_eq_u32 s55, 3
    s_cbranch_scc0 concat_heads__mha_block__mha_block__prompt_kernel_evw1_3
    s_waitcnt vmcnt(6)
    s_branch concat_heads__mha_block__mha_block__prompt_kernel_evx1
concat_heads__mha_block__mha_block__prompt_kernel_evw1_3:
    s_waitcnt vmcnt(0)
concat_heads__mha_block__mha_block__prompt_kernel_evx1:
    s_waitcnt lgkmcnt(10)
    v_mfma_f32_16x16x32_bf16 v[24:27], v[44:47], v[84:87], v[24:27]
    ds_read_b64_tr_b16 v[44:45], v16 offset:12800
    ds_read_b64_tr_b16 v[46:47], v16 offset:14080
    v_mfma_f32_16x16x32_bf16 v[28:31], v[48:51], v[84:87], v[28:31]
    ds_read_b64_tr_b16 v[48:49], v16 offset:12832
    ds_read_b64_tr_b16 v[50:51], v16 offset:14112
    v_mfma_f32_16x16x32_bf16 v[32:35], v[52:55], v[84:87], v[32:35]
    ds_read_b64_tr_b16 v[52:53], v16 offset:12864
    ds_read_b64_tr_b16 v[54:55], v16 offset:14144
    v_mfma_f32_16x16x32_bf16 v[36:39], v[56:59], v[84:87], v[36:39]
    ds_read_b64_tr_b16 v[56:57], v16 offset:12896
    ds_read_b64_tr_b16 v[58:59], v16 offset:14176
    v_mfma_f32_16x16x32_bf16 v[40:43], v[60:63], v[84:87], v[40:43]
    ds_read_b64_tr_b16 v[60:61], v16 offset:12928
    ds_read_b64_tr_b16 v[62:63], v16 offset:14208
    s_waitcnt lgkmcnt(10)
    v_mfma_f32_16x16x32_bf16 v[24:27], v[64:67], v[88:91], v[24:27]
    ds_read_b64_tr_b16 v[64:65], v16 offset:19200
    ds_read_b64_tr_b16 v[66:67], v16 offset:20480
    v_mfma_f32_16x16x32_bf16 v[28:31], v[68:71], v[88:91], v[28:31]
    ds_read_b64_tr_b16 v[68:69], v16 offset:19232
    ds_read_b64_tr_b16 v[70:71], v16 offset:20512
    v_mfma_f32_16x16x32_bf16 v[32:35], v[72:75], v[88:91], v[32:35]
    ds_read_b64_tr_b16 v[72:73], v16 offset:19264
    ds_read_b64_tr_b16 v[74:75], v16 offset:20544
    v_mfma_f32_16x16x32_bf16 v[36:39], v[76:79], v[88:91], v[36:39]
    ds_read_b64_tr_b16 v[76:77], v16 offset:19296
    ds_read_b64_tr_b16 v[78:79], v16 offset:20576
    v_mfma_f32_16x16x32_bf16 v[40:43], v[80:83], v[88:91], v[40:43]
    ds_read_b64_tr_b16 v[80:81], v16 offset:19328
    ds_read_b64_tr_b16 v[82:83], v16 offset:20608
    s_waitcnt lgkmcnt(10)
    v_mfma_f32_16x16x32_bf16 v[24:27], v[44:47], v[92:95], v[24:27]
    ds_read_b64_tr_b16 v[44:45], v20 offset:0
    ds_read_b64_tr_b16 v[46:47], v20 offset:12800
    v_mfma_f32_16x16x32_bf16 v[28:31], v[48:51], v[92:95], v[28:31]
    ds_read_b64_tr_b16 v[48:49], v20 offset:32
    ds_read_b64_tr_b16 v[50:51], v20 offset:12832
    v_mfma_f32_16x16x32_bf16 v[32:35], v[52:55], v[92:95], v[32:35]
    ds_read_b64_tr_b16 v[52:53], v20 offset:64
    ds_read_b64_tr_b16 v[54:55], v20 offset:12864
    v_mfma_f32_16x16x32_bf16 v[36:39], v[56:59], v[92:95], v[36:39]
    ds_read_b64_tr_b16 v[56:57], v20 offset:96
    ds_read_b64_tr_b16 v[58:59], v20 offset:12896
    v_mfma_f32_16x16x32_bf16 v[40:43], v[60:63], v[92:95], v[40:43]
    ds_read_b64_tr_b16 v[60:61], v20 offset:128
    ds_read_b64_tr_b16 v[62:63], v20 offset:12928
    s_waitcnt lgkmcnt(10)
    v_mfma_f32_16x16x32_bf16 v[24:27], v[64:67], v[96:99], v[24:27]
    v_mfma_f32_16x16x32_bf16 v[28:31], v[68:71], v[96:99], v[28:31]
    v_mfma_f32_16x16x32_bf16 v[32:35], v[72:75], v[96:99], v[32:35]
    v_mfma_f32_16x16x32_bf16 v[36:39], v[76:79], v[96:99], v[36:39]
    v_mfma_f32_16x16x32_bf16 v[40:43], v[80:83], v[96:99], v[40:43]
    s_waitcnt lgkmcnt(0)
    v_mfma_f32_16x16x32_bf16 v[24:27], v[44:47], v[100:103], v[24:27]
    v_mfma_f32_16x16x32_bf16 v[28:31], v[48:51], v[100:103], v[28:31]
    v_mfma_f32_16x16x32_bf16 v[32:35], v[52:55], v[100:103], v[32:35]
    v_mfma_f32_16x16x32_bf16 v[36:39], v[56:59], v[100:103], v[36:39]
    v_mfma_f32_16x16x32_bf16 v[40:43], v[60:63], v[100:103], v[40:43]
    s_mov_b32 s44, 2
    s_branch concat_heads__mha_block__mha_block__prompt_kernel_ev
concat_heads__mha_block__mha_block__prompt_kernel_evk1:
    s_cmp_eq_u32 s44, 2
    s_cbranch_scc0 concat_heads__mha_block__mha_block__prompt_kernel_evk2
    ds_read_b64_tr_b16 v[44:45], v17 offset:0
    ds_read_b64_tr_b16 v[46:47], v17 offset:1280
    ds_read_b64_tr_b16 v[48:49], v17 offset:32
    ds_read_b64_tr_b16 v[50:51], v17 offset:1312
    ds_read_b64_tr_b16 v[52:53], v17 offset:64
    ds_read_b64_tr_b16 v[54:55], v17 offset:1344
    ds_read_b64_tr_b16 v[56:57], v17 offset:96
    ds_read_b64_tr_b16 v[58:59], v17 offset:1376
    ds_read_b64_tr_b16 v[60:61], v17 offset:128
    ds_read_b64_tr_b16 v[62:63], v17 offset:1408
    ds_read_b64_tr_b16 v[64:65], v17 offset:6400
    ds_read_b64_tr_b16 v[66:67], v17 offset:7680
    ds_read_b64_tr_b16 v[68:69], v17 offset:6432
    ds_read_b64_tr_b16 v[70:71], v17 offset:7712
    ds_read_b64_tr_b16 v[72:73], v17 offset:6464
    ds_read_b64_tr_b16 v[74:75], v17 offset:7744
    ds_read_b64_tr_b16 v[76:77], v17 offset:6496
    ds_read_b64_tr_b16 v[78:79], v17 offset:7776
    ds_read_b64_tr_b16 v[80:81], v17 offset:6528
    ds_read_b64_tr_b16 v[82:83], v17 offset:7808
    s_cmp_eq_u32 s55, 4
    s_cbranch_scc0 concat_heads__mha_block__mha_block__prompt_kernel_evw2_4
    s_waitcnt vmcnt(6)
    s_branch concat_heads__mha_block__mha_block__prompt_kernel_evx2
concat_heads__mha_block__mha_block__prompt_kernel_evw2_4:
    s_waitcnt vmcnt(0)
concat_heads__mha_block__mha_block__prompt_kernel_evx2:
    s_waitcnt lgkmcnt(10)
    v_mfma_f32_16x16x32_bf16 v[24:27], v[44:47], v[104:107], v[24:27]
    ds_read_b64_tr_b16 v[44:45], v17 offset:12800
    ds_read_b64_tr_b16 v[46:47], v17 offset:14080
    v_mfma_f32_16x16x32_bf16 v[28:31], v[48:51], v[104:107], v[28:31]
    ds_read_b64_tr_b16 v[48:49], v17 offset:12832
    ds_read_b64_tr_b16 v[50:51], v17 offset:14112
    v_mfma_f32_16x16x32_bf16 v[32:35], v[52:55], v[104:107], v[32:35]
    ds_read_b64_tr_b16 v[52:53], v17 offset:12864
    ds_read_b64_tr_b16 v[54:55], v17 offset:14144
    v_mfma_f32_16x16x32_bf16 v[36:39], v[56:59], v[104:107], v[36:39]
    ds_read_b64_tr_b16 v[56:57], v17 offset:12896
    ds_read_b64_tr_b16 v[58:59], v17 offset:14176
    v_mfma_f32_16x16x32_bf16 v[40:43], v[60:63], v[104:107], v[40:43]
    ds_read_b64_tr_b16 v[60:61], v17 offset:12928
    ds_read_b64_tr_b16 v[62:63], v17 offset:14208
    s_waitcnt lgkmcnt(10)
    v_mfma_f32_16x16x32_bf16 v[24:27], v[64:67], v[108:111], v[24:27]
    ds_read_b64_tr_b16 v[64:65], v17 offset:19200
    ds_read_b64_tr_b16 v[66:67], v17 offset:20480
    v_mfma_f32_16x16x32_bf16 v[28:31], v[68:71], v[108:111], v[28:31]
    ds_read_b64_tr_b16 v[68:69], v17 offset:19232
    ds_read_b64_tr_b16 v[70:71], v17 offset:20512
    v_mfma_f32_16x16x32_bf16 v[32:35], v[72:75], v[108:111], v[32:35]
    ds_read_b64_tr_b16 v[72:73], v17 offset:19264
    ds_read_b64_tr_b16 v[74:75], v17 offset:20544
    v_mfma_f32_16x16x32_bf16 v[36:39], v[76:79], v[108:111], v[36:39]
    ds_read_b64_tr_b16 v[76:77], v17 offset:19296
    ds_read_b64_tr_b16 v[78:79], v17 offset:20576
    v_mfma_f32_16x16x32_bf16 v[40:43], v[80:83], v[108:111], v[40:43]
    ds_read_b64_tr_b16 v[80:81], v17 offset:19328
    ds_read_b64_tr_b16 v[82:83], v17 offset:20608
    s_waitcnt lgkmcnt(10)
    v_mfma_f32_16x16x32_bf16 v[24:27], v[44:47], v[112:115], v[24:27]
    ds_read_b64_tr_b16 v[44:45], v21 offset:0
    ds_read_b64_tr_b16 v[46:47], v21 offset:12800
    v_mfma_f32_16x16x32_bf16 v[28:31], v[48:51], v[112:115], v[28:31]
    ds_read_b64_tr_b16 v[48:49], v21 offset:32
    ds_read_b64_tr_b16 v[50:51], v21 offset:12832
    v_mfma_f32_16x16x32_bf16 v[32:35], v[52:55], v[112:115], v[32:35]
    ds_read_b64_tr_b16 v[52:53], v21 offset:64
    ds_read_b64_tr_b16 v[54:55], v21 offset:12864
    v_mfma_f32_16x16x32_bf16 v[36:39], v[56:59], v[112:115], v[36:39]
    ds_read_b64_tr_b16 v[56:57], v21 offset:96
    ds_read_b64_tr_b16 v[58:59], v21 offset:12896
    v_mfma_f32_16x16x32_bf16 v[40:43], v[60:63], v[112:115], v[40:43]
    ds_read_b64_tr_b16 v[60:61], v21 offset:128
    ds_read_b64_tr_b16 v[62:63], v21 offset:12928
    s_waitcnt lgkmcnt(10)
    v_mfma_f32_16x16x32_bf16 v[24:27], v[64:67], v[116:119], v[24:27]
    v_mfma_f32_16x16x32_bf16 v[28:31], v[68:71], v[116:119], v[28:31]
    v_mfma_f32_16x16x32_bf16 v[32:35], v[72:75], v[116:119], v[32:35]
    v_mfma_f32_16x16x32_bf16 v[36:39], v[76:79], v[116:119], v[36:39]
    v_mfma_f32_16x16x32_bf16 v[40:43], v[80:83], v[116:119], v[40:43]
    s_waitcnt lgkmcnt(0)
    v_mfma_f32_16x16x32_bf16 v[24:27], v[44:47], v[120:123], v[24:27]
    v_mfma_f32_16x16x32_bf16 v[28:31], v[48:51], v[120:123], v[28:31]
    v_mfma_f32_16x16x32_bf16 v[32:35], v[52:55], v[120:123], v[32:35]
    v_mfma_f32_16x16x32_bf16 v[36:39], v[56:59], v[120:123], v[36:39]
    v_mfma_f32_16x16x32_bf16 v[40:43], v[60:63], v[120:123], v[40:43]
    s_mov_b32 s44, 3
    s_branch concat_heads__mha_block__mha_block__prompt_kernel_ev
concat_heads__mha_block__mha_block__prompt_kernel_evk2:
    ds_read_b64_tr_b16 v[44:45], v18 offset:0
    ds_read_b64_tr_b16 v[46:47], v18 offset:1280
    ds_read_b64_tr_b16 v[48:49], v18 offset:32
    ds_read_b64_tr_b16 v[50:51], v18 offset:1312
    ds_read_b64_tr_b16 v[52:53], v18 offset:64
    ds_read_b64_tr_b16 v[54:55], v18 offset:1344
    ds_read_b64_tr_b16 v[56:57], v18 offset:96
    ds_read_b64_tr_b16 v[58:59], v18 offset:1376
    ds_read_b64_tr_b16 v[60:61], v18 offset:128
    ds_read_b64_tr_b16 v[62:63], v18 offset:1408
    ds_read_b64_tr_b16 v[64:65], v18 offset:6400
    ds_read_b64_tr_b16 v[66:67], v18 offset:7680
    ds_read_b64_tr_b16 v[68:69], v18 offset:6432
    ds_read_b64_tr_b16 v[70:71], v18 offset:7712
    ds_read_b64_tr_b16 v[72:73], v18 offset:6464
    ds_read_b64_tr_b16 v[74:75], v18 offset:7744
    ds_read_b64_tr_b16 v[76:77], v18 offset:6496
    ds_read_b64_tr_b16 v[78:79], v18 offset:7776
    ds_read_b64_tr_b16 v[80:81], v18 offset:6528
    ds_read_b64_tr_b16 v[82:83], v18 offset:7808
    s_waitcnt vmcnt(0)
concat_heads__mha_block__mha_block__prompt_kernel_evx3:
    s_waitcnt lgkmcnt(10)
    v_mfma_f32_16x16x32_bf16 v[24:27], v[44:47], v[124:127], v[24:27]
    ds_read_b64_tr_b16 v[44:45], v18 offset:12800
    ds_read_b64_tr_b16 v[46:47], v18 offset:14080
    v_mfma_f32_16x16x32_bf16 v[28:31], v[48:51], v[124:127], v[28:31]
    ds_read_b64_tr_b16 v[48:49], v18 offset:12832
    ds_read_b64_tr_b16 v[50:51], v18 offset:14112
    v_mfma_f32_16x16x32_bf16 v[32:35], v[52:55], v[124:127], v[32:35]
    ds_read_b64_tr_b16 v[52:53], v18 offset:12864
    ds_read_b64_tr_b16 v[54:55], v18 offset:14144
    v_mfma_f32_16x16x32_bf16 v[36:39], v[56:59], v[124:127], v[36:39]
    ds_read_b64_tr_b16 v[56:57], v18 offset:12896
    ds_read_b64_tr_b16 v[58:59], v18 offset:14176
    v_mfma_f32_16x16x32_bf16 v[40:43], v[60:63], v[124:127], v[40:43]
    ds_read_b64_tr_b16 v[60:61], v18 offset:12928
    ds_read_b64_tr_b16 v[62:63], v18 offset:14208
    s_waitcnt lgkmcnt(10)
    v_mfma_f32_16x16x32_bf16 v[24:27], v[64:67], v[128:131], v[24:27]
    ds_read_b64_tr_b16 v[64:65], v18 offset:19200
    ds_read_b64_tr_b16 v[66:67], v18 offset:20480
    v_mfma_f32_16x16x32_bf16 v[28:31], v[68:71], v[128:131], v[28:31]
    ds_read_b64_tr_b16 v[68:69], v18 offset:19232
    ds_read_b64_tr_b16 v[70:71], v18 offset:20512
    v_mfma_f32_16x16x32_bf16 v[32:35], v[72:75], v[128:131], v[32:35]
    ds_read_b64_tr_b16 v[72:73], v18 offset:19264
    ds_read_b64_tr_b16 v[74:75], v18 offset:20544
    v_mfma_f32_16x16x32_bf16 v[36:39], v[76:79], v[128:131], v[36:39]
    ds_read_b64_tr_b16 v[76:77], v18 offset:19296
    ds_read_b64_tr_b16 v[78:79], v18 offset:20576
    v_mfma_f32_16x16x32_bf16 v[40:43], v[80:83], v[128:131], v[40:43]
    ds_read_b64_tr_b16 v[80:81], v18 offset:19328
    ds_read_b64_tr_b16 v[82:83], v18 offset:20608
    s_waitcnt lgkmcnt(10)
    v_mfma_f32_16x16x32_bf16 v[24:27], v[44:47], v[132:135], v[24:27]
    ds_read_b64_tr_b16 v[44:45], v22 offset:0
    ds_read_b64_tr_b16 v[46:47], v22 offset:12800
    v_mfma_f32_16x16x32_bf16 v[28:31], v[48:51], v[132:135], v[28:31]
    ds_read_b64_tr_b16 v[48:49], v22 offset:32
    ds_read_b64_tr_b16 v[50:51], v22 offset:12832
    v_mfma_f32_16x16x32_bf16 v[32:35], v[52:55], v[132:135], v[32:35]
    ds_read_b64_tr_b16 v[52:53], v22 offset:64
    ds_read_b64_tr_b16 v[54:55], v22 offset:12864
    v_mfma_f32_16x16x32_bf16 v[36:39], v[56:59], v[132:135], v[36:39]
    ds_read_b64_tr_b16 v[56:57], v22 offset:96
    ds_read_b64_tr_b16 v[58:59], v22 offset:12896
    v_mfma_f32_16x16x32_bf16 v[40:43], v[60:63], v[132:135], v[40:43]
    ds_read_b64_tr_b16 v[60:61], v22 offset:128
    ds_read_b64_tr_b16 v[62:63], v22 offset:12928
    s_waitcnt lgkmcnt(10)
    v_mfma_f32_16x16x32_bf16 v[24:27], v[64:67], v[136:139], v[24:27]
    v_mfma_f32_16x16x32_bf16 v[28:31], v[68:71], v[136:139], v[28:31]
    v_mfma_f32_16x16x32_bf16 v[32:35], v[72:75], v[136:139], v[32:35]
    v_mfma_f32_16x16x32_bf16 v[36:39], v[76:79], v[136:139], v[36:39]
    v_mfma_f32_16x16x32_bf16 v[40:43], v[80:83], v[136:139], v[40:43]
    s_waitcnt lgkmcnt(0)
    v_mfma_f32_16x16x32_bf16 v[24:27], v[44:47], v[140:143], v[24:27]
    v_mfma_f32_16x16x32_bf16 v[28:31], v[48:51], v[140:143], v[28:31]
    v_mfma_f32_16x16x32_bf16 v[32:35], v[52:55], v[140:143], v[32:35]
    v_mfma_f32_16x16x32_bf16 v[36:39], v[56:59], v[140:143], v[36:39]
    v_mfma_f32_16x16x32_bf16 v[40:43], v[60:63], v[140:143], v[40:43]
    s_nop 3
    v_cvt_pk_bf16_f32 v24, v24, v25
    v_cvt_pk_bf16_f32 v25, v26, v27
    ds_write_b64 v166, v[24:25] offset:0
    v_cvt_pk_bf16_f32 v28, v28, v29
    v_cvt_pk_bf16_f32 v29, v30, v31
    ds_write_b64 v166, v[28:29] offset:32
    v_cvt_pk_bf16_f32 v32, v32, v33
    v_cvt_pk_bf16_f32 v33, v34, v35
    ds_write_b64 v166, v[32:33] offset:64
    v_cvt_pk_bf16_f32 v36, v36, v37
    v_cvt_pk_bf16_f32 v37, v38, v39
    ds_write_b64 v166, v[36:37] offset:96
    v_cvt_pk_bf16_f32 v40, v40, v41
    v_cvt_pk_bf16_f32 v41, v42, v43
    ds_write_b64 v166, v[40:41] offset:128
    s_waitcnt lgkmcnt(0)
    ds_read_b128 v[44:47], v167 offset:0
    ds_read_b128 v[48:51], v167 offset:1024
    ds_read_b128 v[52:55], v167 offset:2048
    s_waitcnt lgkmcnt(2)
    buffer_store_dwordx4 v[44:47], v12, s[28:31], s46 offen sc1
    s_waitcnt lgkmcnt(1)
    buffer_store_dwordx4 v[48:51], v13, s[28:31], s46 offen sc1
    s_waitcnt lgkmcnt(0)
    buffer_store_dwordx4 v[52:55], v14, s[28:31], s46 offen sc1
concat_heads__mha_block__mha_block__prompt_kernel_done:
    s_endpgm
concat_heads__mha_block__mha_block__prompt_kernel_fallback:
    v_cndmask_b32_e64 v36, v36, 0, s[42:43]
    v_cndmask_b32_e64 v37, v37, 0, s[42:43]
    v_cndmask_b32_e64 v38, v38, 0, s[42:43]
    v_cndmask_b32_e64 v39, v39, 0, s[42:43]
    v_mov_b32 v6, 0xff800000
    v_mov_b32 v7, 0xff800000
    v_mov_b32 v3, 1073741824
    s_lshr_b32 s36, s32, 1
    s_mul_i32 s36, s36, 10240
    v_subrev_u32 v2, s36, v14
    v_cmp_eq_u32 vcc, 1, v16
    s_mov_b32 s36, s47
    s_mov_b32 s44, 0
    v_cndmask_b32 v138, v3, v2, vcc
    s_mov_b64 s[50:51], vcc
    s_waitcnt vmcnt(0)
concat_heads__mha_block__mha_block__prompt_kernel_fb1:
    buffer_load_dwordx4 v[40:43], v17, s[16:19], s36 offen sc1
    buffer_load_dwordx2 v[48:49], v18, s[16:19], s36 offen sc1
    s_waitcnt vmcnt(0)
    v_mfma_f32_32x32x16_bf16 v[100:115], v[40:43], v[28:31], 0
    v_mfma_f32_32x32x16_bf16 v[116:131], v[40:43], v[32:35], 0
    v_mfma_f32_32x32x8_bf16 v[100:115], v[48:49], v[36:37], v[100:115]
    v_mfma_f32_32x32x8_bf16 v[116:131], v[48:49], v[38:39], v[116:131]
    s_nop 15
    v_max3_f32 v2, v100, v101, v102
    v_max3_f32 v2, v2, v103, v104
    v_max3_f32 v2, v2, v105, v106
    v_max3_f32 v2, v2, v107, v108
    v_max3_f32 v2, v2, v109, v110
    v_max3_f32 v2, v2, v111, v112
    v_max3_f32 v2, v2, v113, v114
    v_max_f32 v2, v2, v115
    v_max_f32 v6, v6, v2
    v_max3_f32 v2, v116, v117, v118
    v_max3_f32 v2, v2, v119, v120
    v_max3_f32 v2, v2, v121, v122
    v_max3_f32 v2, v2, v123, v124
    v_max3_f32 v2, v2, v125, v126
    v_max3_f32 v2, v2, v127, v128
    v_max3_f32 v2, v2, v129, v130
    v_max_f32 v2, v2, v131
    v_max_f32 v7, v7, v2
    s_add_u32 s36, s36, 2560
    s_add_u32 s44, s44, 1
    s_cmp_lt_u32 s44, 64
    s_cbranch_scc1 concat_heads__mha_block__mha_block__prompt_kernel_fb1
    v_mov_b32 v3, v6
    s_nop 1
    v_permlane32_swap_b32 v6, v3
    s_nop 1
    v_max_f32 v6, v6, v3
    v_mov_b32 v68, 0
    v_mov_b32 v69, 0
    v_mov_b32 v70, 0
    v_mov_b32 v71, 0
    v_mov_b32 v72, 0
    v_mov_b32 v73, 0
    v_mov_b32 v74, 0
    v_mov_b32 v75, 0
    v_mov_b32 v76, 0
    v_mov_b32 v77, 0
    v_mov_b32 v78, 0
    v_mov_b32 v79, 0
    v_mov_b32 v80, 0
    v_mov_b32 v81, 0
    v_mov_b32 v82, 0
    v_mov_b32 v83, 0
    v_mov_b32 v3, v7
    s_nop 1
    v_permlane32_swap_b32 v7, v3
    s_nop 1
    v_max_f32 v7, v7, v3
    v_mov_b32 v84, 0
    v_mov_b32 v85, 0
    v_mov_b32 v86, 0
    v_mov_b32 v87, 0
    v_mov_b32 v88, 0
    v_mov_b32 v89, 0
    v_mov_b32 v90, 0
    v_mov_b32 v91, 0
    v_mov_b32 v92, 0
    v_mov_b32 v93, 0
    v_mov_b32 v94, 0
    v_mov_b32 v95, 0
    v_mov_b32 v96, 0
    v_mov_b32 v97, 0
    v_mov_b32 v98, 0
    v_mov_b32 v99, 0
    s_mov_b32 s36, s47
    s_mov_b32 s44, 0
    v_mov_b32 v3, 0x3f803f80
concat_heads__mha_block__mha_block__prompt_kernel_fb2:
    buffer_load_dwordx4 v[40:43], v17, s[16:19], s36 offen sc1
    buffer_load_dwordx2 v[48:49], v18, s[16:19], s36 offen sc1
    buffer_load_dwordx4 v[52:55], v138, s[16:19], s36 offen sc1
    buffer_load_dwordx4 v[60:63], v138, s[16:19], s36 offen offset:640 sc1
    s_waitcnt vmcnt(0)
    v_mfma_f32_32x32x16_bf16 v[100:115], v[40:43], v[28:31], 0
    v_mfma_f32_32x32x16_bf16 v[116:131], v[40:43], v[32:35], 0
    v_mfma_f32_32x32x8_bf16 v[100:115], v[48:49], v[36:37], v[100:115]
    v_mfma_f32_32x32x8_bf16 v[116:131], v[48:49], v[38:39], v[116:131]
    v_cndmask_b32_e64 v52, v3, v52, s[50:51]
    v_cndmask_b32_e64 v60, v3, v60, s[50:51]
    v_cndmask_b32_e64 v53, v3, v53, s[50:51]
    v_cndmask_b32_e64 v61, v3, v61, s[50:51]
    v_cndmask_b32_e64 v54, v3, v54, s[50:51]
    v_cndmask_b32_e64 v62, v3, v62, s[50:51]
    v_cndmask_b32_e64 v55, v3, v55, s[50:51]
    v_cndmask_b32_e64 v63, v3, v63, s[50:51]
    s_nop 15
    v_sub_f32 v100, v100, v6
    v_sub_f32 v101, v101, v6
    v_sub_f32 v102, v102, v6
    v_sub_f32 v103, v103, v6
    v_sub_f32 v104, v104, v6
    v_sub_f32 v105, v105, v6
    v_sub_f32 v106, v106, v6
    v_sub_f32 v107, v107, v6
    v_sub_f32 v108, v108, v6
    v_sub_f32 v109, v109, v6
    v_sub_f32 v110, v110, v6
    v_sub_f32 v111, v111, v6
    v_sub_f32 v112, v112, v6
    v_sub_f32 v113, v113, v6
    v_sub_f32 v114, v114, v6
    v_sub_f32 v115, v115, v6
    v_exp_f32 v100, v100
    v_exp_f32 v101, v101
    v_exp_f32 v102, v102
    v_exp_f32 v103, v103
    v_exp_f32 v104, v104
    v_exp_f32 v105, v105
    v_exp_f32 v106, v106
    v_exp_f32 v107, v107
    v_exp_f32 v108, v108
    v_exp_f32 v109, v109
    v_exp_f32 v110, v110
    v_exp_f32 v111, v111
    v_exp_f32 v112, v112
    v_exp_f32 v113, v113
    v_exp_f32 v114, v114
    v_exp_f32 v115, v115
    v_sub_f32 v116, v116, v7
    v_sub_f32 v117, v117, v7
    v_sub_f32 v118, v118, v7
    v_sub_f32 v119, v119, v7
    v_sub_f32 v120, v120, v7
    v_sub_f32 v121, v121, v7
    v_sub_f32 v122, v122, v7
    v_sub_f32 v123, v123, v7
    v_sub_f32 v124, v124, v7
    v_sub_f32 v125, v125, v7
    v_sub_f32 v126, v126, v7
    v_sub_f32 v127, v127, v7
    v_sub_f32 v128, v128, v7
    v_sub_f32 v129, v129, v7
    v_sub_f32 v130, v130, v7
    v_sub_f32 v131, v131, v7
    v_exp_f32 v116, v116
    v_exp_f32 v117, v117
    v_exp_f32 v118, v118
    v_exp_f32 v119, v119
    v_exp_f32 v120, v120
    v_exp_f32 v121, v121
    v_exp_f32 v122, v122
    v_exp_f32 v123, v123
    v_exp_f32 v124, v124
    v_exp_f32 v125, v125
    v_exp_f32 v126, v126
    v_exp_f32 v127, v127
    v_exp_f32 v128, v128
    v_exp_f32 v129, v129
    v_exp_f32 v130, v130
    v_exp_f32 v131, v131
    s_nop 1
    v_smfmac_f32_32x32x32_bf16 v[68:83], v[52:55], v[100:107], v8
    v_smfmac_f32_32x32x32_bf16 v[68:83], v[60:63], v[108:115], v8
    v_smfmac_f32_32x32x32_bf16 v[84:99], v[52:55], v[116:123], v8
    v_smfmac_f32_32x32x32_bf16 v[84:99], v[60:63], v[124:131], v8
    s_add_u32 s36, s36, 2560
    s_add_u32 s44, s44, 1
    s_cmp_lt_u32 s44, 64
    s_cbranch_scc1 concat_heads__mha_block__mha_block__prompt_kernel_fb2
    s_nop 15
    s_mov_b32 s55, 1
    s_branch concat_heads__mha_block__mha_block__prompt_kernel_store
concat_heads__mha_block__mha_block__prompt_kernel_helper:
    s_setprio 3
    s_lshr_b32 s36, s2, 3
    s_and_b32 s37, s2, 1
    s_lshl_b32 s37, s37, 5
    s_add_u32 s37, s37, s36
    s_lshl_b32 s37, s37, 5
    v_and_b32 v2, 31, v1
    v_add_u32 v4, s37, v2
    v_mul_u32_u24 v4, 1280, v4
    v_lshrrev_b32 v3, 5, v1
    v_lshl_add_u32 v100, v3, 7, v4
    v_cmp_le_u32 vcc, 15, v2
    s_lshl_b32 s36, s36, 1
    s_bfe_u32 s37, s2, 0x10001
    v_cndmask_b32_e64 v4, 0, 1, vcc
    v_mul_u32_u24 v5, 15, v4
    v_sub_u32 v5, v2, v5
    v_lshl_add_u32 v4, v3, 6, v4
    v_add_u32 v4, s36, v4
    v_mul_u32_u24 v4, 3840, v4
    v_mul_u32_u24 v6, 52, v5
    v_lshrrev_b32 v6, 8, v6
    v_mul_u32_u24 v6, 640, v6
    v_lshl_add_u32 v6, v5, 7, v6
    s_mul_i32 s37, s37, 640
    v_add3_u32 v101, v4, v6, s37
    v_cmp_le_u32 vcc, 30, v2
    v_mov_b32 v4, 1073741824
    s_nop 0
    v_cndmask_b32 v101, v101, v4, vcc
    s_waitcnt lgkmcnt(0)
    s_mov_b32 s12, s10
    s_mov_b32 s13, s11
    s_mov_b32 s20, s30
    s_mov_b32 s21, s31
    s_mov_b32 s16, s6
    s_mov_b32 s17, s7
    s_mov_b32 s10, 2621440
    s_mov_b32 s11, 0x20000
    s_mov_b32 s14, 2457600
    s_mov_b32 s15, 0x20000
    s_mov_b32 s18, 15806720
    s_mov_b32 s19, 0x20000
    s_mov_b32 s22, 256
    s_mov_b32 s23, 0x20000
    s_mov_b32 s26, 819200
    s_mov_b32 s27, 0x20000
    s_mov_b32 s30, 5242880
    s_mov_b32 s31, 0x20000
    s_lshl_b32 s55, s33, 7
    s_add_u32 s55, s55, 15740928
    s_load_dword s61, s[6:7], s55
    buffer_load_dword v102, v100, s[8:11], 0 offen offset:0
    s_mov_b32 s36, 0
    buffer_load_dword v103, v101, s[12:15], s36 offen
    buffer_load_dword v102, v100, s[8:11], 0 offen offset:256
    s_mov_b32 s36, 491520
    buffer_load_dword v103, v101, s[12:15], s36 offen
    v_lshlrev_b32 v9, 4, v1
    s_bfe_u32 s36, s2, 196611
    s_and_b32 s55, s2, 1
    s_lshl_b32 s55, s55, 3
    s_add_u32 s55, s55, s36
    s_lshl_b32 s55, s55, 7
    v_add_u32 v2, s55, v1
    v_mul_u32_u24 v54, 1280, v2
    v_mul_u32_u24 v3, 4370, v1
    v_lshrrev_b32 v3, 16, v3
    v_mul_u32_u24 v4, 15, v3
    v_sub_u32 v5, v1, v4
    s_lshl_b32 s36, s36, 3
    v_add_u32 v3, s36, v3
    v_mul_u32_u24 v3, 3840, v3
    v_mul_u32_u24 v6, 52, v5
    v_lshrrev_b32 v6, 8, v6
    v_mul_u32_u24 v6, 640, v6
    v_lshl_add_u32 v6, v5, 7, v6
    v_add3_u32 v55, v3, v6, s37
    v_cmp_le_u32 vcc, 60, v1
    v_mov_b32 v4, 1073741824
    s_lshr_b32 s39, s2, 6
    v_cndmask_b32 v55, v55, v4, vcc
    s_lshl_b32 s36, s34, 7
    v_lshrrev_b32 v2, 3, v1
    v_add_u32 v2, s36, v2
    v_mul_u32_u24 v2, 1280, v2
    v_lshrrev_b32 v3, 4, v1
    v_and_b32 v5, 7, v1
    v_xor_b32 v4, v3, v5
    v_lshl_add_u32 v35, v4, 4, v2
    v_xor_b32 v4, 64, v35
    v_add_u32 v36, 9216, v4
    v_add_u32 v37, 18432, v35
    v_add_u32 v38, 27648, v4
    s_sub_u32 s36, s38, 0
    v_add_u32 v2, 0, v1
    v_mul_u32_u24 v3, 2185, v2
    v_lshrrev_b32 v3, 16, v3
    v_mul_u32_u24 v4, 30, v3
    v_sub_u32 v2, v2, v4
    v_and_b32 v4, 0x13, v3
    v_bfe_u32 v5, v3, 2, 1
    v_lshl_or_b32 v4, v5, 3, v4
    v_bfe_u32 v5, v3, 3, 1
    v_lshl_or_b32 v4, v5, 2, v4
    v_mul_u32_u24 v4, 3840, v4
    v_mul_u32_u24 v3, 26, v2
    v_lshrrev_b32 v3, 8, v3
    v_mul_u32_u24 v3, 1120, v3
    v_lshl_add_u32 v2, v2, 4, v3
    v_add3_u32 v39, v2, v4, s36
    s_sub_u32 s36, s38, 1024
    v_add_u32 v2, 64, v1
    v_mul_u32_u24 v3, 2185, v2
    v_lshrrev_b32 v3, 16, v3
    v_mul_u32_u24 v4, 30, v3
    v_sub_u32 v2, v2, v4
    v_and_b32 v4, 0x13, v3
    v_bfe_u32 v5, v3, 2, 1
    v_lshl_or_b32 v4, v5, 3, v4
    v_bfe_u32 v5, v3, 3, 1
    v_lshl_or_b32 v4, v5, 2, v4
    v_mul_u32_u24 v4, 3840, v4
    v_mul_u32_u24 v3, 26, v2
    v_lshrrev_b32 v3, 8, v3
    v_mul_u32_u24 v3, 1120, v3
    v_lshl_add_u32 v2, v2, 4, v3
    v_add3_u32 v40, v2, v4, s36
    s_sub_u32 s36, s38, 2048
    v_add_u32 v2, 128, v1
    v_mul_u32_u24 v3, 2185, v2
    v_lshrrev_b32 v3, 16, v3
    v_mul_u32_u24 v4, 30, v3
    v_sub_u32 v2, v2, v4
    v_and_b32 v4, 0x13, v3
    v_bfe_u32 v5, v3, 2, 1
    v_lshl_or_b32 v4, v5, 3, v4
    v_bfe_u32 v5, v3, 3, 1
    v_lshl_or_b32 v4, v5, 2, v4
    v_mul_u32_u24 v4, 3840, v4
    v_mul_u32_u24 v3, 26, v2
    v_lshrrev_b32 v3, 8, v3
    v_mul_u32_u24 v3, 1120, v3
    v_lshl_add_u32 v2, v2, 4, v3
    v_add3_u32 v41, v2, v4, s36
    s_sub_u32 s36, s38, 3072
    v_add_u32 v2, 192, v1
    v_mul_u32_u24 v3, 2185, v2
    v_lshrrev_b32 v3, 16, v3
    v_mul_u32_u24 v4, 30, v3
    v_sub_u32 v2, v2, v4
    v_and_b32 v4, 0x13, v3
    v_bfe_u32 v5, v3, 2, 1
    v_lshl_or_b32 v4, v5, 3, v4
    v_bfe_u32 v5, v3, 3, 1
    v_lshl_or_b32 v4, v5, 2, v4
    v_mul_u32_u24 v4, 3840, v4
    v_mul_u32_u24 v3, 26, v2
    v_lshrrev_b32 v3, 8, v3
    v_mul_u32_u24 v3, 1120, v3
    v_lshl_add_u32 v2, v2, 4, v3
    v_add3_u32 v42, v2, v4, s36
    s_sub_u32 s36, s38, 0
    v_add_u32 v2, 256, v1
    v_mul_u32_u24 v3, 2185, v2
    v_lshrrev_b32 v3, 16, v3
    v_mul_u32_u24 v4, 30, v3
    v_sub_u32 v2, v2, v4
    v_and_b32 v4, 0x13, v3
    v_bfe_u32 v5, v3, 2, 1
    v_lshl_or_b32 v4, v5, 3, v4
    v_bfe_u32 v5, v3, 3, 1
    v_lshl_or_b32 v4, v5, 2, v4
    v_mul_u32_u24 v4, 3840, v4
    v_mul_u32_u24 v3, 26, v2
    v_lshrrev_b32 v3, 8, v3
    v_mul_u32_u24 v3, 1120, v3
    v_lshl_add_u32 v2, v2, 4, v3
    v_add3_u32 v43, v2, v4, s36
    s_sub_u32 s36, s38, 1024
    v_add_u32 v2, 320, v1
    v_mul_u32_u24 v3, 2185, v2
    v_lshrrev_b32 v3, 16, v3
    v_mul_u32_u24 v4, 30, v3
    v_sub_u32 v2, v2, v4
    v_and_b32 v4, 0x13, v3
    v_bfe_u32 v5, v3, 2, 1
    v_lshl_or_b32 v4, v5, 3, v4
    v_bfe_u32 v5, v3, 3, 1
    v_lshl_or_b32 v4, v5, 2, v4
    v_mul_u32_u24 v4, 3840, v4
    v_mul_u32_u24 v3, 26, v2
    v_lshrrev_b32 v3, 8, v3
    v_mul_u32_u24 v3, 1120, v3
    v_lshl_add_u32 v2, v2, 4, v3
    v_add3_u32 v44, v2, v4, s36
    s_sub_u32 s36, s38, 2048
    v_add_u32 v2, 384, v1
    v_mul_u32_u24 v3, 2185, v2
    v_lshrrev_b32 v3, 16, v3
    v_mul_u32_u24 v4, 30, v3
    v_sub_u32 v2, v2, v4
    v_and_b32 v4, 0x13, v3
    v_bfe_u32 v5, v3, 2, 1
    v_lshl_or_b32 v4, v5, 3, v4
    v_bfe_u32 v5, v3, 3, 1
    v_lshl_or_b32 v4, v5, 2, v4
    v_mul_u32_u24 v4, 3840, v4
    v_mul_u32_u24 v3, 26, v2
    v_lshrrev_b32 v3, 8, v3
    v_mul_u32_u24 v3, 1120, v3
    v_lshl_add_u32 v2, v2, 4, v3
    v_add3_u32 v45, v2, v4, s36
    s_sub_u32 s36, s38, 3072
    v_add_u32 v2, 448, v1
    v_mul_u32_u24 v3, 2185, v2
    v_lshrrev_b32 v3, 16, v3
    v_mul_u32_u24 v4, 30, v3
    v_sub_u32 v2, v2, v4
    v_and_b32 v4, 0x13, v3
    v_bfe_u32 v5, v3, 2, 1
    v_lshl_or_b32 v4, v5, 3, v4
    v_bfe_u32 v5, v3, 3, 1
    v_lshl_or_b32 v4, v5, 2, v4
    v_mul_u32_u24 v4, 3840, v4
    v_mul_u32_u24 v3, 26, v2
    v_lshrrev_b32 v3, 8, v3
    v_mul_u32_u24 v3, 1120, v3
    v_lshl_add_u32 v2, v2, 4, v3
    v_add3_u32 v46, v2, v4, s36
    s_sub_u32 s36, s38, 0
    v_add_u32 v2, 512, v1
    v_mul_u32_u24 v3, 2185, v2
    v_lshrrev_b32 v3, 16, v3
    v_mul_u32_u24 v4, 30, v3
    v_sub_u32 v2, v2, v4
    v_and_b32 v4, 0x13, v3
    v_bfe_u32 v5, v3, 2, 1
    v_lshl_or_b32 v4, v5, 3, v4
    v_bfe_u32 v5, v3, 3, 1
    v_lshl_or_b32 v4, v5, 2, v4
    v_mul_u32_u24 v4, 3840, v4
    v_mul_u32_u24 v3, 26, v2
    v_lshrrev_b32 v3, 8, v3
    v_mul_u32_u24 v3, 1120, v3
    v_lshl_add_u32 v2, v2, 4, v3
    v_add3_u32 v47, v2, v4, s36
    s_sub_u32 s36, s38, 1024
    v_add_u32 v2, 576, v1
    v_mul_u32_u24 v3, 2185, v2
    v_lshrrev_b32 v3, 16, v3
    v_mul_u32_u24 v4, 30, v3
    v_sub_u32 v2, v2, v4
    v_and_b32 v4, 0x13, v3
    v_bfe_u32 v5, v3, 2, 1
    v_lshl_or_b32 v4, v5, 3, v4
    v_bfe_u32 v5, v3, 3, 1
    v_lshl_or_b32 v4, v5, 2, v4
    v_mul_u32_u24 v4, 3840, v4
    v_mul_u32_u24 v3, 26, v2
    v_lshrrev_b32 v3, 8, v3
    v_mul_u32_u24 v3, 1120, v3
    v_lshl_add_u32 v2, v2, 4, v3
    v_add3_u32 v48, v2, v4, s36
    s_sub_u32 s36, s38, 2048
    v_add_u32 v2, 640, v1
    v_mul_u32_u24 v3, 2185, v2
    v_lshrrev_b32 v3, 16, v3
    v_mul_u32_u24 v4, 30, v3
    v_sub_u32 v2, v2, v4
    v_and_b32 v4, 0x13, v3
    v_bfe_u32 v5, v3, 2, 1
    v_lshl_or_b32 v4, v5, 3, v4
    v_bfe_u32 v5, v3, 3, 1
    v_lshl_or_b32 v4, v5, 2, v4
    v_mul_u32_u24 v4, 3840, v4
    v_mul_u32_u24 v3, 26, v2
    v_lshrrev_b32 v3, 8, v3
    v_mul_u32_u24 v3, 1120, v3
    v_lshl_add_u32 v2, v2, 4, v3
    v_add3_u32 v49, v2, v4, s36
    s_sub_u32 s36, s38, 3072
    v_add_u32 v2, 704, v1
    v_mul_u32_u24 v3, 2185, v2
    v_lshrrev_b32 v3, 16, v3
    v_mul_u32_u24 v4, 30, v3
    v_sub_u32 v2, v2, v4
    v_and_b32 v4, 0x13, v3
    v_bfe_u32 v5, v3, 2, 1
    v_lshl_or_b32 v4, v5, 3, v4
    v_bfe_u32 v5, v3, 3, 1
    v_lshl_or_b32 v4, v5, 2, v4
    v_mul_u32_u24 v4, 3840, v4
    v_mul_u32_u24 v3, 26, v2
    v_lshrrev_b32 v3, 8, v3
    v_mul_u32_u24 v3, 1120, v3
    v_lshl_add_u32 v2, v2, 4, v3
    v_add3_u32 v50, v2, v4, s36
    s_sub_u32 s36, s38, 0
    v_add_u32 v2, 768, v1
    v_mul_u32_u24 v3, 2185, v2
    v_lshrrev_b32 v3, 16, v3
    v_mul_u32_u24 v4, 30, v3
    v_sub_u32 v2, v2, v4
    v_and_b32 v4, 0x13, v3
    v_bfe_u32 v5, v3, 2, 1
    v_lshl_or_b32 v4, v5, 3, v4
    v_bfe_u32 v5, v3, 3, 1
    v_lshl_or_b32 v4, v5, 2, v4
    v_mul_u32_u24 v4, 3840, v4
    v_mul_u32_u24 v3, 26, v2
    v_lshrrev_b32 v3, 8, v3
    v_mul_u32_u24 v3, 1120, v3
    v_lshl_add_u32 v2, v2, 4, v3
    v_add3_u32 v51, v2, v4, s36
    s_sub_u32 s36, s38, 1024
    v_add_u32 v2, 832, v1
    v_mul_u32_u24 v3, 2185, v2
    v_lshrrev_b32 v3, 16, v3
    v_mul_u32_u24 v4, 30, v3
    v_sub_u32 v2, v2, v4
    v_and_b32 v4, 0x13, v3
    v_bfe_u32 v5, v3, 2, 1
    v_lshl_or_b32 v4, v5, 3, v4
    v_bfe_u32 v5, v3, 3, 1
    v_lshl_or_b32 v4, v5, 2, v4
    v_mul_u32_u24 v4, 3840, v4
    v_mul_u32_u24 v3, 26, v2
    v_lshrrev_b32 v3, 8, v3
    v_mul_u32_u24 v3, 1120, v3
    v_lshl_add_u32 v2, v2, 4, v3
    v_add3_u32 v52, v2, v4, s36
    s_sub_u32 s36, s38, 2048
    v_add_u32 v2, 896, v1
    v_mul_u32_u24 v3, 2185, v2
    v_lshrrev_b32 v3, 16, v3
    v_mul_u32_u24 v4, 30, v3
    v_sub_u32 v2, v2, v4
    v_and_b32 v4, 0x13, v3
    v_bfe_u32 v5, v3, 2, 1
    v_lshl_or_b32 v4, v5, 3, v4
    v_bfe_u32 v5, v3, 3, 1
    v_lshl_or_b32 v4, v5, 2, v4
    v_mul_u32_u24 v4, 3840, v4
    v_mul_u32_u24 v3, 26, v2
    v_lshrrev_b32 v3, 8, v3
    v_mul_u32_u24 v3, 1120, v3
    v_lshl_add_u32 v2, v2, 4, v3
    v_add3_u32 v53, v2, v4, s36
    s_mov_b32 s56, 47104
    s_barrier
    s_add_u32 s36, s3, 3
    s_and_b32 s37, s36, 3
    s_cmp_eq_u32 s37, s39
    s_cselect_b32 s37, s36, 99
    s_cmp_lt_u32 s37, 4
    s_cselect_b32 s37, 99, s37
    s_cmp_lt_u32 s37, 10
    s_cbranch_scc0 concat_heads__mha_block__mha_block__prompt_kernel_sp0
    s_lshl_b32 s37, s36, 7
    buffer_load_dword v102, v54, s[8:11], s37 offen
    s_add_u32 s37, s37, 81920
    buffer_load_dword v103, v54, s[8:11], s37 offen
    s_mul_i32 s37, s36, 245760
    buffer_load_dword v104, v55, s[12:15], s37 offen
    s_add_u32 s37, s37, 15360
    buffer_load_dword v105, v55, s[12:15], s37 offen
concat_heads__mha_block__mha_block__prompt_kernel_sp0:
    s_add_u32 s3, s3, 1
    s_cmp_eq_u32 s3, 10
    s_cselect_b32 s3, 0, s3
    s_lshl_b32 s53, s3, 7
    s_mul_i32 s54, s3, 245760
    s_add_u32 m0, s56, 0
    s_add_u32 s36, s53, 0
    buffer_load_dwordx4 v35, s[8:11], s36 offen offset:0 lds
    buffer_load_dwordx4 v36, s[8:11], s36 offen offset:1024 lds
    buffer_load_dwordx4 v37, s[8:11], s36 offen offset:2048 lds
    buffer_load_dwordx4 v38, s[8:11], s36 offen offset:3072 lds
    s_add_u32 m0, s56, 4096
    s_add_u32 s36, s53, 40960
    buffer_load_dwordx4 v35, s[8:11], s36 offen offset:0 lds
    buffer_load_dwordx4 v36, s[8:11], s36 offen offset:1024 lds
    buffer_load_dwordx4 v37, s[8:11], s36 offen offset:2048 lds
    buffer_load_dwordx4 v38, s[8:11], s36 offen offset:3072 lds
    s_add_u32 m0, s56, 8192
    s_add_u32 s36, s53, 81920
    buffer_load_dwordx4 v35, s[8:11], s36 offen offset:0 lds
    buffer_load_dwordx4 v36, s[8:11], s36 offen offset:1024 lds
    buffer_load_dwordx4 v37, s[8:11], s36 offen offset:2048 lds
    buffer_load_dwordx4 v38, s[8:11], s36 offen offset:3072 lds
    s_add_u32 m0, s56, 12288
    s_add_u32 s36, s53, 122880
    buffer_load_dwordx4 v35, s[8:11], s36 offen offset:0 lds
    buffer_load_dwordx4 v36, s[8:11], s36 offen offset:1024 lds
    buffer_load_dwordx4 v37, s[8:11], s36 offen offset:2048 lds
    buffer_load_dwordx4 v38, s[8:11], s36 offen offset:3072 lds
    s_add_u32 m0, s56, 16384
    s_add_u32 s36, s54, 0
    buffer_load_dwordx4 v39, s[12:15], s36 offen offset:0 lds
    buffer_load_dwordx4 v40, s[12:15], s36 offen offset:1024 lds
    buffer_load_dwordx4 v41, s[12:15], s36 offen offset:2048 lds
    buffer_load_dwordx4 v42, s[12:15], s36 offen offset:3072 lds
    s_add_u32 m0, s56, 20480
    s_add_u32 s36, s54, 0
    buffer_load_dwordx4 v43, s[12:15], s36 offen offset:0 lds
    buffer_load_dwordx4 v44, s[12:15], s36 offen offset:1024 lds
    buffer_load_dwordx4 v45, s[12:15], s36 offen offset:2048 lds
    buffer_load_dwordx4 v46, s[12:15], s36 offen offset:3072 lds
    s_add_u32 m0, s56, 24576
    s_add_u32 s36, s54, 0
    buffer_load_dwordx4 v47, s[12:15], s36 offen offset:0 lds
    buffer_load_dwordx4 v48, s[12:15], s36 offen offset:1024 lds
    buffer_load_dwordx4 v49, s[12:15], s36 offen offset:2048 lds
    buffer_load_dwordx4 v50, s[12:15], s36 offen offset:3072 lds
    s_add_u32 m0, s56, 28672
    s_add_u32 s36, s54, 0
    buffer_load_dwordx4 v51, s[12:15], s36 offen offset:0 lds
    buffer_load_dwordx4 v52, s[12:15], s36 offen offset:1024 lds
    buffer_load_dwordx4 v53, s[12:15], s36 offen offset:2048 lds
    s_add_u32 m0, s56, 31744
    s_add_u32 s36, s54, 122880
    buffer_load_dwordx4 v39, s[12:15], s36 offen offset:0 lds
    buffer_load_dwordx4 v40, s[12:15], s36 offen offset:1024 lds
    buffer_load_dwordx4 v41, s[12:15], s36 offen offset:2048 lds
    buffer_load_dwordx4 v42, s[12:15], s36 offen offset:3072 lds
    s_add_u32 m0, s56, 35840
    s_add_u32 s36, s54, 122880
    buffer_load_dwordx4 v43, s[12:15], s36 offen offset:0 lds
    buffer_load_dwordx4 v44, s[12:15], s36 offen offset:1024 lds
    buffer_load_dwordx4 v45, s[12:15], s36 offen offset:2048 lds
    buffer_load_dwordx4 v46, s[12:15], s36 offen offset:3072 lds
    s_add_u32 m0, s56, 39936
    s_add_u32 s36, s54, 122880
    buffer_load_dwordx4 v47, s[12:15], s36 offen offset:0 lds
    buffer_load_dwordx4 v48, s[12:15], s36 offen offset:1024 lds
    buffer_load_dwordx4 v49, s[12:15], s36 offen offset:2048 lds
    buffer_load_dwordx4 v50, s[12:15], s36 offen offset:3072 lds
    s_add_u32 m0, s56, 44032
    s_add_u32 s36, s54, 122880
    buffer_load_dwordx4 v51, s[12:15], s36 offen offset:0 lds
    buffer_load_dwordx4 v52, s[12:15], s36 offen offset:1024 lds
    buffer_load_dwordx4 v53, s[12:15], s36 offen offset:2048 lds
    s_add_u32 s56, s56, 47104
    s_cmp_ge_u32 s56, 141312
    s_cselect_b32 s56, 0, s56
    s_barrier
    s_mov_b32 s55, 0
concat_heads__mha_block__mha_block__prompt_kernel_hg:
    s_add_u32 s36, s3, 3
    s_and_b32 s37, s36, 3
    s_cmp_eq_u32 s37, s39
    s_cselect_b32 s37, s36, 99
    s_cmp_lt_u32 s37, 4
    s_cselect_b32 s37, 99, s37
    s_cmp_lt_u32 s37, 10
    s_cbranch_scc0 concat_heads__mha_block__mha_block__prompt_kernel_sp1
    s_lshl_b32 s37, s36, 7
    buffer_load_dword v102, v54, s[8:11], s37 offen
    s_add_u32 s37, s37, 81920
    buffer_load_dword v103, v54, s[8:11], s37 offen
    s_mul_i32 s37, s36, 245760
    buffer_load_dword v104, v55, s[12:15], s37 offen
    s_add_u32 s37, s37, 15360
    buffer_load_dword v105, v55, s[12:15], s37 offen
concat_heads__mha_block__mha_block__prompt_kernel_sp1:
    s_add_u32 s3, s3, 1
    s_cmp_eq_u32 s3, 10
    s_cselect_b32 s3, 0, s3
    s_lshl_b32 s53, s3, 7
    s_mul_i32 s54, s3, 245760
    s_add_u32 m0, s56, 0
    s_add_u32 s36, s53, 0
    buffer_load_dwordx4 v35, s[8:11], s36 offen offset:0 lds
    buffer_load_dwordx4 v36, s[8:11], s36 offen offset:1024 lds
    buffer_load_dwordx4 v37, s[8:11], s36 offen offset:2048 lds
    buffer_load_dwordx4 v38, s[8:11], s36 offen offset:3072 lds
    s_add_u32 m0, s56, 4096
    s_add_u32 s36, s53, 40960
    buffer_load_dwordx4 v35, s[8:11], s36 offen offset:0 lds
    buffer_load_dwordx4 v36, s[8:11], s36 offen offset:1024 lds
    buffer_load_dwordx4 v37, s[8:11], s36 offen offset:2048 lds
    buffer_load_dwordx4 v38, s[8:11], s36 offen offset:3072 lds
    s_add_u32 m0, s56, 8192
    s_add_u32 s36, s53, 81920
    buffer_load_dwordx4 v35, s[8:11], s36 offen offset:0 lds
    buffer_load_dwordx4 v36, s[8:11], s36 offen offset:1024 lds
    buffer_load_dwordx4 v37, s[8:11], s36 offen offset:2048 lds
    buffer_load_dwordx4 v38, s[8:11], s36 offen offset:3072 lds
    s_add_u32 m0, s56, 12288
    s_add_u32 s36, s53, 122880
    buffer_load_dwordx4 v35, s[8:11], s36 offen offset:0 lds
    buffer_load_dwordx4 v36, s[8:11], s36 offen offset:1024 lds
    buffer_load_dwordx4 v37, s[8:11], s36 offen offset:2048 lds
    buffer_load_dwordx4 v38, s[8:11], s36 offen offset:3072 lds
    s_add_u32 m0, s56, 16384
    s_add_u32 s36, s54, 0
    buffer_load_dwordx4 v39, s[12:15], s36 offen offset:0 lds
    buffer_load_dwordx4 v40, s[12:15], s36 offen offset:1024 lds
    buffer_load_dwordx4 v41, s[12:15], s36 offen offset:2048 lds
    buffer_load_dwordx4 v42, s[12:15], s36 offen offset:3072 lds
    s_add_u32 m0, s56, 20480
    s_add_u32 s36, s54, 0
    buffer_load_dwordx4 v43, s[12:15], s36 offen offset:0 lds
    buffer_load_dwordx4 v44, s[12:15], s36 offen offset:1024 lds
    buffer_load_dwordx4 v45, s[12:15], s36 offen offset:2048 lds
    buffer_load_dwordx4 v46, s[12:15], s36 offen offset:3072 lds
    s_add_u32 m0, s56, 24576
    s_add_u32 s36, s54, 0
    buffer_load_dwordx4 v47, s[12:15], s36 offen offset:0 lds
    buffer_load_dwordx4 v48, s[12:15], s36 offen offset:1024 lds
    buffer_load_dwordx4 v49, s[12:15], s36 offen offset:2048 lds
    buffer_load_dwordx4 v50, s[12:15], s36 offen offset:3072 lds
    s_add_u32 m0, s56, 28672
    s_add_u32 s36, s54, 0
    buffer_load_dwordx4 v51, s[12:15], s36 offen offset:0 lds
    buffer_load_dwordx4 v52, s[12:15], s36 offen offset:1024 lds
    buffer_load_dwordx4 v53, s[12:15], s36 offen offset:2048 lds
    s_add_u32 m0, s56, 31744
    s_add_u32 s36, s54, 122880
    buffer_load_dwordx4 v39, s[12:15], s36 offen offset:0 lds
    buffer_load_dwordx4 v40, s[12:15], s36 offen offset:1024 lds
    buffer_load_dwordx4 v41, s[12:15], s36 offen offset:2048 lds
    buffer_load_dwordx4 v42, s[12:15], s36 offen offset:3072 lds
    s_add_u32 m0, s56, 35840
    s_add_u32 s36, s54, 122880
    buffer_load_dwordx4 v43, s[12:15], s36 offen offset:0 lds
    buffer_load_dwordx4 v44, s[12:15], s36 offen offset:1024 lds
    buffer_load_dwordx4 v45, s[12:15], s36 offen offset:2048 lds
    buffer_load_dwordx4 v46, s[12:15], s36 offen offset:3072 lds
    s_add_u32 m0, s56, 39936
    s_add_u32 s36, s54, 122880
    buffer_load_dwordx4 v47, s[12:15], s36 offen offset:0 lds
    buffer_load_dwordx4 v48, s[12:15], s36 offen offset:1024 lds
    buffer_load_dwordx4 v49, s[12:15], s36 offen offset:2048 lds
    buffer_load_dwordx4 v50, s[12:15], s36 offen offset:3072 lds
    s_add_u32 m0, s56, 44032
    s_add_u32 s36, s54, 122880
    buffer_load_dwordx4 v51, s[12:15], s36 offen offset:0 lds
    buffer_load_dwordx4 v52, s[12:15], s36 offen offset:1024 lds
    buffer_load_dwordx4 v53, s[12:15], s36 offen offset:2048 lds
    s_add_u32 s56, s56, 47104
    s_cmp_ge_u32 s56, 141312
    s_cselect_b32 s56, 0, s56
    s_waitcnt vmcnt(46)
    s_barrier
    s_add_u32 s55, s55, 1
    s_cmp_lt_u32 s55, 8
    s_cbranch_scc1 concat_heads__mha_block__mha_block__prompt_kernel_hg
    s_lshl_b32 s36, s33, 3
    s_add_u32 s36, s36, s35
    s_lshl_b32 s36, s36, 8
    s_add_u32 s36, s36, 15728640
    s_mov_b32 s39, s36
    v_lshl_add_u32 v2, v1, 2, s36
    v_cmp_gt_u32 vcc, 16, v1
    v_mov_b32 v3, 1073741824
    s_lshl_b32 s36, s33, 4
    v_cndmask_b32 v22, v3, v2, vcc
    s_add_u32 s36, s36, s4
    s_lshl_b32 s36, s36, 8
    s_add_u32 s36, s36, 15732736
    s_mov_b32 s40, s36
    v_lshl_add_u32 v2, v1, 2, s36
    v_cmp_gt_u32 vcc, 8, v1
    v_mov_b32 v25, 122880
    s_mul_i32 s38, s5, 160
    v_cndmask_b32 v23, v3, v2, vcc
    v_add_u32 v2, 0, v1
    v_mul_u32_u24 v3, 6554, v2
    v_lshrrev_b32 v3, 16, v3
    v_mul_u32_u24 v3, 1120, v3
    v_lshl_add_u32 v2, v2, 4, v3
    v_add_u32 v2, s38, v2
    v_subrev_u32 v26, 0, v2
    v_add_u32 v2, 64, v1
    v_mul_u32_u24 v3, 6554, v2
    v_lshrrev_b32 v3, 16, v3
    v_mul_u32_u24 v3, 1120, v3
    v_lshl_add_u32 v2, v2, 4, v3
    v_add_u32 v2, s38, v2
    v_subrev_u32 v27, 1024, v2
    v_add_u32 v2, 128, v1
    v_mul_u32_u24 v3, 6554, v2
    v_lshrrev_b32 v3, 16, v3
    v_mul_u32_u24 v3, 1120, v3
    v_lshl_add_u32 v2, v2, 4, v3
    v_add_u32 v2, s38, v2
    v_subrev_u32 v28, 2048, v2
    v_add_u32 v2, 192, v1
    v_mul_u32_u24 v3, 6554, v2
    v_lshrrev_b32 v3, 16, v3
    v_mul_u32_u24 v3, 1120, v3
    v_lshl_add_u32 v2, v2, 4, v3
    v_add_u32 v2, s38, v2
    v_subrev_u32 v29, 3072, v2
    v_add_u32 v2, 256, v1
    v_mul_u32_u24 v3, 6554, v2
    v_lshrrev_b32 v3, 16, v3
    v_mul_u32_u24 v3, 1120, v3
    v_lshl_add_u32 v2, v2, 4, v3
    v_add_u32 v2, s38, v2
    v_subrev_u32 v30, 0, v2
    s_lshr_b32 s36, s2, 3
    s_mul_i32 s36, s36, 25600
    v_lshl_add_u32 v2, v1, 7, s36
    v_cmp_gt_u32 vcc, 50, v1
    v_mov_b32 v3, 1073741824
    s_mov_b32 s52, 0
    v_cndmask_b32 v24, v3, v2, vcc
    s_waitcnt lgkmcnt(0)
    s_lshl_b32 s41, 1, s34
    s_waitcnt vmcnt(15)
    s_add_u32 s61, s61, 2654435769
    s_barrier
    buffer_load_dword v11, v22, s[16:19], 0 offen sc1
    v_bfe_u32 v4, v1, 1, 2
    v_mul_u32_u24 v4, 2560, v4
    v_and_b32 v5, 1, v1
    v_mul_u32_u24 v5, 640, v5
    v_add_u32 v4, v4, v5
    v_add_u32 v4, 123008, v4
    v_mov_b32 v12, 0x3f803f80
    v_mov_b32 v13, 0x3f803f80
    v_mov_b32 v14, 0x3f803f80
    v_mov_b32 v15, 0x3f803f80
    v_mov_b32 v16, 0
    v_mov_b32 v17, 0
    v_mov_b32 v18, 0
    v_mov_b32 v19, 0
    s_mov_b32 s55, 1
    s_mov_b32 s56, 81920
    s_waitcnt vmcnt(0)
    s_barrier
    v_cmp_eq_u32 vcc, s61, v11
    s_and_b32 s52, vcc_lo, 0xffff
    s_andn2_b32 s36, s52, s41
    s_cbranch_scc0 concat_heads__mha_block__mha_block__prompt_kernel_ne
    s_lshl_b32 s37, s36, 16
    s_or_b32 s36, s36, s37
    s_lshr_b32 s36, s36, s34
    s_ff1_i32_b32 s36, s36
    s_add_u32 s54, s36, s34
    s_and_b32 s54, s54, 15
    s_bitset1_b32 s41, s54
    s_mul_i32 s36, s54, 10240
    s_add_u32 s57, s47, s36
    s_add_u32 m0, s56, 0
    s_add_u32 s36, s57, 0
    buffer_load_dwordx4 v9, s[16:19], s36 offen offset:0 sc1 lds
    buffer_load_dwordx4 v9, s[16:19], s36 offen offset:1024 sc1 lds
    buffer_load_dwordx4 v9, s[16:19], s36 offen offset:2048 sc1 lds
    buffer_load_dwordx4 v9, s[16:19], s36 offen offset:3072 sc1 lds
    s_add_u32 m0, s56, 4096
    s_add_u32 s36, s57, 4096
    buffer_load_dwordx4 v9, s[16:19], s36 offen offset:0 sc1 lds
    buffer_load_dwordx4 v9, s[16:19], s36 offen offset:1024 sc1 lds
    buffer_load_dwordx4 v9, s[16:19], s36 offen offset:2048 sc1 lds
    buffer_load_dwordx4 v9, s[16:19], s36 offen offset:3072 sc1 lds
    s_add_u32 m0, s56, 8192
    s_add_u32 s36, s57, 8192
    buffer_load_dwordx4 v9, s[16:19], s36 offen offset:0 sc1 lds
    buffer_load_dwordx4 v9, s[16:19], s36 offen offset:1024 sc1 lds
    s_add_u32 m0, s56, 10240
    s_add_u32 s36, s57, 163840
    buffer_load_dwordx4 v9, s[16:19], s36 offen offset:0 sc1 lds
    buffer_load_dwordx4 v9, s[16:19], s36 offen offset:1024 sc1 lds
    buffer_load_dwordx4 v9, s[16:19], s36 offen offset:2048 sc1 lds
    buffer_load_dwordx4 v9, s[16:19], s36 offen offset:3072 sc1 lds
    s_add_u32 m0, s56, 14336
    s_add_u32 s36, s57, 167936
    buffer_load_dwordx4 v9, s[16:19], s36 offen offset:0 sc1 lds
    buffer_load_dwordx4 v9, s[16:19], s36 offen offset:1024 sc1 lds
    buffer_load_dwordx4 v9, s[16:19], s36 offen offset:2048 sc1 lds
    buffer_load_dwordx4 v9, s[16:19], s36 offen offset:3072 sc1 lds
    s_add_u32 m0, s56, 18432
    s_add_u32 s36, s57, 172032
    buffer_load_dwordx4 v9, s[16:19], s36 offen offset:0 sc1 lds
    buffer_load_dwordx4 v9, s[16:19], s36 offen offset:1024 sc1 lds
    s_barrier
    ds_write_b128 v4, v[12:15]
    ds_write_b128 v4, v[16:19] offset:16
    ds_write_b128 v25, v[16:19]
    ds_write_b128 v25, v[16:19] offset:16
    s_add_u32 m0, s56, 20480
    s_add_u32 s36, s57, 327680
    buffer_load_dwordx4 v9, s[16:19], s36 offen offset:0 sc1 lds
    buffer_load_dwordx4 v9, s[16:19], s36 offen offset:1024 sc1 lds
    buffer_load_dwordx4 v9, s[16:19], s36 offen offset:2048 sc1 lds
    buffer_load_dwordx4 v9, s[16:19], s36 offen offset:3072 sc1 lds
    s_add_u32 m0, s56, 24576
    s_add_u32 s36, s57, 331776
    buffer_load_dwordx4 v9, s[16:19], s36 offen offset:0 sc1 lds
    buffer_load_dwordx4 v9, s[16:19], s36 offen offset:1024 sc1 lds
    buffer_load_dwordx4 v9, s[16:19], s36 offen offset:2048 sc1 lds
    buffer_load_dwordx4 v9, s[16:19], s36 offen offset:3072 sc1 lds
    s_add_u32 m0, s56, 28672
    s_add_u32 s36, s57, 335872
    buffer_load_dwordx4 v9, s[16:19], s36 offen offset:0 sc1 lds
    buffer_load_dwordx4 v9, s[16:19], s36 offen offset:1024 sc1 lds
    s_add_u32 m0, s56, 30720
    s_add_u32 s36, s57, 491520
    buffer_load_dwordx4 v9, s[16:19], s36 offen offset:0 sc1 lds
    buffer_load_dwordx4 v9, s[16:19], s36 offen offset:1024 sc1 lds
    buffer_load_dwordx4 v9, s[16:19], s36 offen offset:2048 sc1 lds
    buffer_load_dwordx4 v9, s[16:19], s36 offen offset:3072 sc1 lds
    s_add_u32 m0, s56, 34816
    s_add_u32 s36, s57, 495616
    buffer_load_dwordx4 v9, s[16:19], s36 offen offset:0 sc1 lds
    buffer_load_dwordx4 v9, s[16:19], s36 offen offset:1024 sc1 lds
    buffer_load_dwordx4 v9, s[16:19], s36 offen offset:2048 sc1 lds
    buffer_load_dwordx4 v9, s[16:19], s36 offen offset:3072 sc1 lds
    s_add_u32 m0, s56, 38912
    s_add_u32 s36, s57, 499712
    buffer_load_dwordx4 v9, s[16:19], s36 offen offset:0 sc1 lds
    buffer_load_dwordx4 v9, s[16:19], s36 offen offset:1024 sc1 lds
    s_sub_u32 s56, s56, 40960
    s_cselect_b32 s56, 81920, s56
    s_add_u32 s55, s55, 1
    s_waitcnt lgkmcnt(0)
    s_barrier
    s_barrier
    s_branch concat_heads__mha_block__mha_block__prompt_kernel_g1d
concat_heads__mha_block__mha_block__prompt_kernel_ne:
    s_barrier
    ds_write_b128 v4, v[12:15]
    ds_write_b128 v4, v[16:19] offset:16
    ds_write_b128 v25, v[16:19]
    ds_write_b128 v25, v[16:19] offset:16
    s_waitcnt lgkmcnt(0)
    s_barrier
    s_barrier
    s_andn2_b32 s36, s52, s41
    s_cbranch_scc1 concat_heads__mha_block__mha_block__prompt_kernel_pd0
    s_mov_b32 s53, 262144
concat_heads__mha_block__mha_block__prompt_kernel_pl0:
    s_load_dwordx16 s[64:79], s[6:7], s39 glc
    s_mov_b32 s52, 0
    s_waitcnt lgkmcnt(0)
    s_cmp_eq_u32 s79, s61
    s_addc_u32 s52, s52, s52
    s_cmp_eq_u32 s78, s61
    s_addc_u32 s52, s52, s52
    s_cmp_eq_u32 s77, s61
    s_addc_u32 s52, s52, s52
    s_cmp_eq_u32 s76, s61
    s_addc_u32 s52, s52, s52
    s_cmp_eq_u32 s75, s61
    s_addc_u32 s52, s52, s52
    s_cmp_eq_u32 s74, s61
    s_addc_u32 s52, s52, s52
    s_cmp_eq_u32 s73, s61
    s_addc_u32 s52, s52, s52
    s_cmp_eq_u32 s72, s61
    s_addc_u32 s52, s52, s52
    s_cmp_eq_u32 s71, s61
    s_addc_u32 s52, s52, s52
    s_cmp_eq_u32 s70, s61
    s_addc_u32 s52, s52, s52
    s_cmp_eq_u32 s69, s61
    s_addc_u32 s52, s52, s52
    s_cmp_eq_u32 s68, s61
    s_addc_u32 s52, s52, s52
    s_cmp_eq_u32 s67, s61
    s_addc_u32 s52, s52, s52
    s_cmp_eq_u32 s66, s61
    s_addc_u32 s52, s52, s52
    s_cmp_eq_u32 s65, s61
    s_addc_u32 s52, s52, s52
    s_cmp_eq_u32 s64, s61
    s_addc_u32 s52, s52, s52
    s_andn2_b32 s36, s52, s41
    s_cbranch_scc1 concat_heads__mha_block__mha_block__prompt_kernel_pd0
    s_sub_u32 s53, s53, 1
    s_cmp_lg_u32 s53, 0
    s_cbranch_scc1 concat_heads__mha_block__mha_block__prompt_kernel_pl0
    s_mov_b32 s52, 0xffff
    s_andn2_b32 s36, s52, s41
concat_heads__mha_block__mha_block__prompt_kernel_pd0:
    s_lshl_b32 s37, s36, 16
    s_or_b32 s36, s36, s37
    s_lshr_b32 s36, s36, s34
    s_ff1_i32_b32 s36, s36
    s_add_u32 s54, s36, s34
    s_and_b32 s54, s54, 15
    s_bitset1_b32 s41, s54
    s_mul_i32 s36, s54, 10240
    s_add_u32 s57, s47, s36
    s_add_u32 m0, s56, 0
    s_add_u32 s36, s57, 0
    buffer_load_dwordx4 v9, s[16:19], s36 offen offset:0 sc1 lds
    buffer_load_dwordx4 v9, s[16:19], s36 offen offset:1024 sc1 lds
    buffer_load_dwordx4 v9, s[16:19], s36 offen offset:2048 sc1 lds
    buffer_load_dwordx4 v9, s[16:19], s36 offen offset:3072 sc1 lds
    s_add_u32 m0, s56, 4096
    s_add_u32 s36, s57, 4096
    buffer_load_dwordx4 v9, s[16:19], s36 offen offset:0 sc1 lds
    buffer_load_dwordx4 v9, s[16:19], s36 offen offset:1024 sc1 lds
    buffer_load_dwordx4 v9, s[16:19], s36 offen offset:2048 sc1 lds
    buffer_load_dwordx4 v9, s[16:19], s36 offen offset:3072 sc1 lds
    s_add_u32 m0, s56, 8192
    s_add_u32 s36, s57, 8192
    buffer_load_dwordx4 v9, s[16:19], s36 offen offset:0 sc1 lds
    buffer_load_dwordx4 v9, s[16:19], s36 offen offset:1024 sc1 lds
    s_add_u32 m0, s56, 10240
    s_add_u32 s36, s57, 163840
    buffer_load_dwordx4 v9, s[16:19], s36 offen offset:0 sc1 lds
    buffer_load_dwordx4 v9, s[16:19], s36 offen offset:1024 sc1 lds
    buffer_load_dwordx4 v9, s[16:19], s36 offen offset:2048 sc1 lds
    buffer_load_dwordx4 v9, s[16:19], s36 offen offset:3072 sc1 lds
    s_add_u32 m0, s56, 14336
    s_add_u32 s36, s57, 167936
    buffer_load_dwordx4 v9, s[16:19], s36 offen offset:0 sc1 lds
    buffer_load_dwordx4 v9, s[16:19], s36 offen offset:1024 sc1 lds
    buffer_load_dwordx4 v9, s[16:19], s36 offen offset:2048 sc1 lds
    buffer_load_dwordx4 v9, s[16:19], s36 offen offset:3072 sc1 lds
    s_add_u32 m0, s56, 18432
    s_add_u32 s36, s57, 172032
    buffer_load_dwordx4 v9, s[16:19], s36 offen offset:0 sc1 lds
    buffer_load_dwordx4 v9, s[16:19], s36 offen offset:1024 sc1 lds
    s_add_u32 m0, s56, 20480
    s_add_u32 s36, s57, 327680
    buffer_load_dwordx4 v9, s[16:19], s36 offen offset:0 sc1 lds
    buffer_load_dwordx4 v9, s[16:19], s36 offen offset:1024 sc1 lds
    buffer_load_dwordx4 v9, s[16:19], s36 offen offset:2048 sc1 lds
    buffer_load_dwordx4 v9, s[16:19], s36 offen offset:3072 sc1 lds
    s_add_u32 m0, s56, 24576
    s_add_u32 s36, s57, 331776
    buffer_load_dwordx4 v9, s[16:19], s36 offen offset:0 sc1 lds
    buffer_load_dwordx4 v9, s[16:19], s36 offen offset:1024 sc1 lds
    buffer_load_dwordx4 v9, s[16:19], s36 offen offset:2048 sc1 lds
    buffer_load_dwordx4 v9, s[16:19], s36 offen offset:3072 sc1 lds
    s_add_u32 m0, s56, 28672
    s_add_u32 s36, s57, 335872
    buffer_load_dwordx4 v9, s[16:19], s36 offen offset:0 sc1 lds
    buffer_load_dwordx4 v9, s[16:19], s36 offen offset:1024 sc1 lds
    s_add_u32 m0, s56, 30720
    s_add_u32 s36, s57, 491520
    buffer_load_dwordx4 v9, s[16:19], s36 offen offset:0 sc1 lds
    buffer_load_dwordx4 v9, s[16:19], s36 offen offset:1024 sc1 lds
    buffer_load_dwordx4 v9, s[16:19], s36 offen offset:2048 sc1 lds
    buffer_load_dwordx4 v9, s[16:19], s36 offen offset:3072 sc1 lds
    s_add_u32 m0, s56, 34816
    s_add_u32 s36, s57, 495616
    buffer_load_dwordx4 v9, s[16:19], s36 offen offset:0 sc1 lds
    buffer_load_dwordx4 v9, s[16:19], s36 offen offset:1024 sc1 lds
    buffer_load_dwordx4 v9, s[16:19], s36 offen offset:2048 sc1 lds
    buffer_load_dwordx4 v9, s[16:19], s36 offen offset:3072 sc1 lds
    s_add_u32 m0, s56, 38912
    s_add_u32 s36, s57, 499712
    buffer_load_dwordx4 v9, s[16:19], s36 offen offset:0 sc1 lds
    buffer_load_dwordx4 v9, s[16:19], s36 offen offset:1024 sc1 lds
    s_sub_u32 s56, s56, 40960
    s_cselect_b32 s56, 81920, s56
    s_add_u32 s55, s55, 1
concat_heads__mha_block__mha_block__prompt_kernel_g1d:
    s_waitcnt vmcnt(0)
    s_barrier
    s_andn2_b32 s36, s52, s41
    s_cbranch_scc1 concat_heads__mha_block__mha_block__prompt_kernel_pd1
    s_mov_b32 s53, 262144
concat_heads__mha_block__mha_block__prompt_kernel_pl1:
    s_load_dwordx16 s[64:79], s[6:7], s39 glc
    s_mov_b32 s52, 0
    s_waitcnt lgkmcnt(0)
    s_cmp_eq_u32 s79, s61
    s_addc_u32 s52, s52, s52
    s_cmp_eq_u32 s78, s61
    s_addc_u32 s52, s52, s52
    s_cmp_eq_u32 s77, s61
    s_addc_u32 s52, s52, s52
    s_cmp_eq_u32 s76, s61
    s_addc_u32 s52, s52, s52
    s_cmp_eq_u32 s75, s61
    s_addc_u32 s52, s52, s52
    s_cmp_eq_u32 s74, s61
    s_addc_u32 s52, s52, s52
    s_cmp_eq_u32 s73, s61
    s_addc_u32 s52, s52, s52
    s_cmp_eq_u32 s72, s61
    s_addc_u32 s52, s52, s52
    s_cmp_eq_u32 s71, s61
    s_addc_u32 s52, s52, s52
    s_cmp_eq_u32 s70, s61
    s_addc_u32 s52, s52, s52
    s_cmp_eq_u32 s69, s61
    s_addc_u32 s52, s52, s52
    s_cmp_eq_u32 s68, s61
    s_addc_u32 s52, s52, s52
    s_cmp_eq_u32 s67, s61
    s_addc_u32 s52, s52, s52
    s_cmp_eq_u32 s66, s61
    s_addc_u32 s52, s52, s52
    s_cmp_eq_u32 s65, s61
    s_addc_u32 s52, s52, s52
    s_cmp_eq_u32 s64, s61
    s_addc_u32 s52, s52, s52
    s_andn2_b32 s36, s52, s41
    s_cbranch_scc1 concat_heads__mha_block__mha_block__prompt_kernel_pd1
    s_sub_u32 s53, s53, 1
    s_cmp_lg_u32 s53, 0
    s_cbranch_scc1 concat_heads__mha_block__mha_block__prompt_kernel_pl1
    s_mov_b32 s52, 0xffff
    s_andn2_b32 s36, s52, s41
concat_heads__mha_block__mha_block__prompt_kernel_pd1:
    s_lshl_b32 s37, s36, 16
    s_or_b32 s36, s36, s37
    s_lshr_b32 s36, s36, s34
    s_ff1_i32_b32 s36, s36
    s_add_u32 s54, s36, s34
    s_and_b32 s54, s54, 15
    s_bitset1_b32 s41, s54
    s_mul_i32 s36, s54, 10240
    s_add_u32 s57, s47, s36
    s_add_u32 m0, s56, 0
    s_add_u32 s36, s57, 0
    buffer_load_dwordx4 v9, s[16:19], s36 offen offset:0 sc1 lds
    buffer_load_dwordx4 v9, s[16:19], s36 offen offset:1024 sc1 lds
    buffer_load_dwordx4 v9, s[16:19], s36 offen offset:2048 sc1 lds
    buffer_load_dwordx4 v9, s[16:19], s36 offen offset:3072 sc1 lds
    s_add_u32 m0, s56, 4096
    s_add_u32 s36, s57, 4096
    buffer_load_dwordx4 v9, s[16:19], s36 offen offset:0 sc1 lds
    buffer_load_dwordx4 v9, s[16:19], s36 offen offset:1024 sc1 lds
    buffer_load_dwordx4 v9, s[16:19], s36 offen offset:2048 sc1 lds
    buffer_load_dwordx4 v9, s[16:19], s36 offen offset:3072 sc1 lds
    s_add_u32 m0, s56, 8192
    s_add_u32 s36, s57, 8192
    buffer_load_dwordx4 v9, s[16:19], s36 offen offset:0 sc1 lds
    buffer_load_dwordx4 v9, s[16:19], s36 offen offset:1024 sc1 lds
    s_add_u32 m0, s56, 10240
    s_add_u32 s36, s57, 163840
    buffer_load_dwordx4 v9, s[16:19], s36 offen offset:0 sc1 lds
    buffer_load_dwordx4 v9, s[16:19], s36 offen offset:1024 sc1 lds
    buffer_load_dwordx4 v9, s[16:19], s36 offen offset:2048 sc1 lds
    buffer_load_dwordx4 v9, s[16:19], s36 offen offset:3072 sc1 lds
    s_add_u32 m0, s56, 14336
    s_add_u32 s36, s57, 167936
    buffer_load_dwordx4 v9, s[16:19], s36 offen offset:0 sc1 lds
    buffer_load_dwordx4 v9, s[16:19], s36 offen offset:1024 sc1 lds
    buffer_load_dwordx4 v9, s[16:19], s36 offen offset:2048 sc1 lds
    buffer_load_dwordx4 v9, s[16:19], s36 offen offset:3072 sc1 lds
    s_add_u32 m0, s56, 18432
    s_add_u32 s36, s57, 172032
    buffer_load_dwordx4 v9, s[16:19], s36 offen offset:0 sc1 lds
    buffer_load_dwordx4 v9, s[16:19], s36 offen offset:1024 sc1 lds
    s_add_u32 m0, s56, 20480
    s_add_u32 s36, s57, 327680
    buffer_load_dwordx4 v9, s[16:19], s36 offen offset:0 sc1 lds
    buffer_load_dwordx4 v9, s[16:19], s36 offen offset:1024 sc1 lds
    buffer_load_dwordx4 v9, s[16:19], s36 offen offset:2048 sc1 lds
    buffer_load_dwordx4 v9, s[16:19], s36 offen offset:3072 sc1 lds
    s_add_u32 m0, s56, 24576
    s_add_u32 s36, s57, 331776
    buffer_load_dwordx4 v9, s[16:19], s36 offen offset:0 sc1 lds
    buffer_load_dwordx4 v9, s[16:19], s36 offen offset:1024 sc1 lds
    buffer_load_dwordx4 v9, s[16:19], s36 offen offset:2048 sc1 lds
    buffer_load_dwordx4 v9, s[16:19], s36 offen offset:3072 sc1 lds
    s_add_u32 m0, s56, 28672
    s_add_u32 s36, s57, 335872
    buffer_load_dwordx4 v9, s[16:19], s36 offen offset:0 sc1 lds
    buffer_load_dwordx4 v9, s[16:19], s36 offen offset:1024 sc1 lds
    s_add_u32 m0, s56, 30720
    s_add_u32 s36, s57, 491520
    buffer_load_dwordx4 v9, s[16:19], s36 offen offset:0 sc1 lds
    buffer_load_dwordx4 v9, s[16:19], s36 offen offset:1024 sc1 lds
    buffer_load_dwordx4 v9, s[16:19], s36 offen offset:2048 sc1 lds
    buffer_load_dwordx4 v9, s[16:19], s36 offen offset:3072 sc1 lds
    s_add_u32 m0, s56, 34816
    s_add_u32 s36, s57, 495616
    buffer_load_dwordx4 v9, s[16:19], s36 offen offset:0 sc1 lds
    buffer_load_dwordx4 v9, s[16:19], s36 offen offset:1024 sc1 lds
    buffer_load_dwordx4 v9, s[16:19], s36 offen offset:2048 sc1 lds
    buffer_load_dwordx4 v9, s[16:19], s36 offen offset:3072 sc1 lds
    s_add_u32 m0, s56, 38912
    s_add_u32 s36, s57, 499712
    buffer_load_dwordx4 v9, s[16:19], s36 offen offset:0 sc1 lds
    buffer_load_dwordx4 v9, s[16:19], s36 offen offset:1024 sc1 lds
    s_sub_u32 s56, s56, 40960
    s_cselect_b32 s56, 81920, s56
    s_add_u32 s55, s55, 1
concat_heads__mha_block__mha_block__prompt_kernel_hl:
    s_andn2_b32 s36, s52, s41
    s_cbranch_scc1 concat_heads__mha_block__mha_block__prompt_kernel_pd2
    s_mov_b32 s53, 262144
concat_heads__mha_block__mha_block__prompt_kernel_pl2:
    s_load_dwordx16 s[64:79], s[6:7], s39 glc
    s_mov_b32 s52, 0
    s_waitcnt lgkmcnt(0)
    s_cmp_eq_u32 s79, s61
    s_addc_u32 s52, s52, s52
    s_cmp_eq_u32 s78, s61
    s_addc_u32 s52, s52, s52
    s_cmp_eq_u32 s77, s61
    s_addc_u32 s52, s52, s52
    s_cmp_eq_u32 s76, s61
    s_addc_u32 s52, s52, s52
    s_cmp_eq_u32 s75, s61
    s_addc_u32 s52, s52, s52
    s_cmp_eq_u32 s74, s61
    s_addc_u32 s52, s52, s52
    s_cmp_eq_u32 s73, s61
    s_addc_u32 s52, s52, s52
    s_cmp_eq_u32 s72, s61
    s_addc_u32 s52, s52, s52
    s_cmp_eq_u32 s71, s61
    s_addc_u32 s52, s52, s52
    s_cmp_eq_u32 s70, s61
    s_addc_u32 s52, s52, s52
    s_cmp_eq_u32 s69, s61
    s_addc_u32 s52, s52, s52
    s_cmp_eq_u32 s68, s61
    s_addc_u32 s52, s52, s52
    s_cmp_eq_u32 s67, s61
    s_addc_u32 s52, s52, s52
    s_cmp_eq_u32 s66, s61
    s_addc_u32 s52, s52, s52
    s_cmp_eq_u32 s65, s61
    s_addc_u32 s52, s52, s52
    s_cmp_eq_u32 s64, s61
    s_addc_u32 s52, s52, s52
    s_andn2_b32 s36, s52, s41
    s_cbranch_scc1 concat_heads__mha_block__mha_block__prompt_kernel_pd2
    s_sub_u32 s53, s53, 1
    s_cmp_lg_u32 s53, 0
    s_cbranch_scc1 concat_heads__mha_block__mha_block__prompt_kernel_pl2
    s_mov_b32 s52, 0xffff
    s_andn2_b32 s36, s52, s41
concat_heads__mha_block__mha_block__prompt_kernel_pd2:
    s_lshl_b32 s37, s36, 16
    s_or_b32 s36, s36, s37
    s_lshr_b32 s36, s36, s34
    s_ff1_i32_b32 s36, s36
    s_add_u32 s54, s36, s34
    s_and_b32 s54, s54, 15
    s_bitset1_b32 s41, s54
    s_mul_i32 s36, s54, 10240
    s_add_u32 s57, s47, s36
    s_add_u32 m0, s56, 0
    s_add_u32 s36, s57, 0
    buffer_load_dwordx4 v9, s[16:19], s36 offen offset:0 sc1 lds
    buffer_load_dwordx4 v9, s[16:19], s36 offen offset:1024 sc1 lds
    buffer_load_dwordx4 v9, s[16:19], s36 offen offset:2048 sc1 lds
    buffer_load_dwordx4 v9, s[16:19], s36 offen offset:3072 sc1 lds
    s_add_u32 m0, s56, 4096
    s_add_u32 s36, s57, 4096
    buffer_load_dwordx4 v9, s[16:19], s36 offen offset:0 sc1 lds
    buffer_load_dwordx4 v9, s[16:19], s36 offen offset:1024 sc1 lds
    buffer_load_dwordx4 v9, s[16:19], s36 offen offset:2048 sc1 lds
    buffer_load_dwordx4 v9, s[16:19], s36 offen offset:3072 sc1 lds
    s_add_u32 m0, s56, 8192
    s_add_u32 s36, s57, 8192
    buffer_load_dwordx4 v9, s[16:19], s36 offen offset:0 sc1 lds
    buffer_load_dwordx4 v9, s[16:19], s36 offen offset:1024 sc1 lds
    s_add_u32 m0, s56, 10240
    s_add_u32 s36, s57, 163840
    buffer_load_dwordx4 v9, s[16:19], s36 offen offset:0 sc1 lds
    buffer_load_dwordx4 v9, s[16:19], s36 offen offset:1024 sc1 lds
    buffer_load_dwordx4 v9, s[16:19], s36 offen offset:2048 sc1 lds
    buffer_load_dwordx4 v9, s[16:19], s36 offen offset:3072 sc1 lds
    s_add_u32 m0, s56, 14336
    s_add_u32 s36, s57, 167936
    buffer_load_dwordx4 v9, s[16:19], s36 offen offset:0 sc1 lds
    buffer_load_dwordx4 v9, s[16:19], s36 offen offset:1024 sc1 lds
    buffer_load_dwordx4 v9, s[16:19], s36 offen offset:2048 sc1 lds
    buffer_load_dwordx4 v9, s[16:19], s36 offen offset:3072 sc1 lds
    s_add_u32 m0, s56, 18432
    s_add_u32 s36, s57, 172032
    buffer_load_dwordx4 v9, s[16:19], s36 offen offset:0 sc1 lds
    buffer_load_dwordx4 v9, s[16:19], s36 offen offset:1024 sc1 lds
    s_add_u32 m0, s56, 20480
    s_add_u32 s36, s57, 327680
    buffer_load_dwordx4 v9, s[16:19], s36 offen offset:0 sc1 lds
    buffer_load_dwordx4 v9, s[16:19], s36 offen offset:1024 sc1 lds
    buffer_load_dwordx4 v9, s[16:19], s36 offen offset:2048 sc1 lds
    buffer_load_dwordx4 v9, s[16:19], s36 offen offset:3072 sc1 lds
    s_add_u32 m0, s56, 24576
    s_add_u32 s36, s57, 331776
    buffer_load_dwordx4 v9, s[16:19], s36 offen offset:0 sc1 lds
    buffer_load_dwordx4 v9, s[16:19], s36 offen offset:1024 sc1 lds
    buffer_load_dwordx4 v9, s[16:19], s36 offen offset:2048 sc1 lds
    buffer_load_dwordx4 v9, s[16:19], s36 offen offset:3072 sc1 lds
    s_add_u32 m0, s56, 28672
    s_add_u32 s36, s57, 335872
    buffer_load_dwordx4 v9, s[16:19], s36 offen offset:0 sc1 lds
    buffer_load_dwordx4 v9, s[16:19], s36 offen offset:1024 sc1 lds
    s_add_u32 m0, s56, 30720
    s_add_u32 s36, s57, 491520
    buffer_load_dwordx4 v9, s[16:19], s36 offen offset:0 sc1 lds
    buffer_load_dwordx4 v9, s[16:19], s36 offen offset:1024 sc1 lds
    buffer_load_dwordx4 v9, s[16:19], s36 offen offset:2048 sc1 lds
    buffer_load_dwordx4 v9, s[16:19], s36 offen offset:3072 sc1 lds
    s_add_u32 m0, s56, 34816
    s_add_u32 s36, s57, 495616
    buffer_load_dwordx4 v9, s[16:19], s36 offen offset:0 sc1 lds
    buffer_load_dwordx4 v9, s[16:19], s36 offen offset:1024 sc1 lds
    buffer_load_dwordx4 v9, s[16:19], s36 offen offset:2048 sc1 lds
    buffer_load_dwordx4 v9, s[16:19], s36 offen offset:3072 sc1 lds
    s_add_u32 m0, s56, 38912
    s_add_u32 s36, s57, 499712
    buffer_load_dwordx4 v9, s[16:19], s36 offen offset:0 sc1 lds
    buffer_load_dwordx4 v9, s[16:19], s36 offen offset:1024 sc1 lds
    s_sub_u32 s56, s56, 40960
    s_cselect_b32 s56, 81920, s56
    s_add_u32 s55, s55, 1
    s_waitcnt vmcnt(40)
    s_barrier
    s_cmp_eq_u32 s55, 6
    s_cbranch_scc0 concat_heads__mha_block__mha_block__prompt_kernel_hnp
    s_mov_b32 s36, 0
    buffer_load_dword v31, v24, s[24:27], s36 offen
    s_mov_b32 s36, 6400
    buffer_load_dword v32, v24, s[24:27], s36 offen
    s_mov_b32 s36, 12800
    buffer_load_dword v33, v24, s[24:27], s36 offen
    s_mov_b32 s36, 19200
    buffer_load_dword v34, v24, s[24:27], s36 offen
concat_heads__mha_block__mha_block__prompt_kernel_hnp:
    s_cmp_eq_u32 s55, 10
    s_cbranch_scc0 concat_heads__mha_block__mha_block__prompt_kernel_hnq
    s_mov_b32 s57, 614400
    s_mov_b32 s37, 131584
concat_heads__mha_block__mha_block__prompt_kernel_hw0x:
    s_mov_b32 m0, s37
    s_add_u32 s36, s37, 4096
    buffer_load_dwordx4 v26, s[24:27], s57 offen offset:0 lds
    buffer_load_dwordx4 v27, s[24:27], s57 offen offset:1024 lds
    buffer_load_dwordx4 v28, s[24:27], s57 offen offset:2048 lds
    buffer_load_dwordx4 v29, s[24:27], s57 offen offset:3072 lds
    s_mov_b32 m0, s36
    s_add_u32 s37, s37, 5120
    buffer_load_dwordx4 v30, s[24:27], s57 offen lds
    s_add_u32 s57, s57, 40960
    s_cmp_lt_u32 s57, 819200
    s_cbranch_scc1 concat_heads__mha_block__mha_block__prompt_kernel_hw0x
concat_heads__mha_block__mha_block__prompt_kernel_hnq:
    s_cmp_lt_u32 s55, 16
    s_cbranch_scc1 concat_heads__mha_block__mha_block__prompt_kernel_hl
    s_mov_b32 s57, 327680
    s_mov_b32 s37, 81920
concat_heads__mha_block__mha_block__prompt_kernel_hw1x:
    s_mov_b32 m0, s37
    s_add_u32 s36, s37, 4096
    buffer_load_dwordx4 v26, s[24:27], s57 offen offset:0 lds
    buffer_load_dwordx4 v27, s[24:27], s57 offen offset:1024 lds
    buffer_load_dwordx4 v28, s[24:27], s57 offen offset:2048 lds
    buffer_load_dwordx4 v29, s[24:27], s57 offen offset:3072 lds
    s_mov_b32 m0, s36
    s_add_u32 s37, s37, 5120
    buffer_load_dwordx4 v30, s[24:27], s57 offen lds
    s_add_u32 s57, s57, 40960
    s_cmp_lt_u32 s57, 614400
    s_cbranch_scc1 concat_heads__mha_block__mha_block__prompt_kernel_hw1x
    s_waitcnt vmcnt(35)
    s_barrier
    s_mov_b32 s57, 0
    s_mov_b32 s37, 40960
concat_heads__mha_block__mha_block__prompt_kernel_hw2x:
    s_mov_b32 m0, s37
    s_add_u32 s36, s37, 4096
    buffer_load_dwordx4 v26, s[24:27], s57 offen offset:0 lds
    buffer_load_dwordx4 v27, s[24:27], s57 offen offset:1024 lds
    buffer_load_dwordx4 v28, s[24:27], s57 offen offset:2048 lds
    buffer_load_dwordx4 v29, s[24:27], s57 offen offset:3072 lds
    s_mov_b32 m0, s36
    s_add_u32 s37, s37, 5120
    buffer_load_dwordx4 v30, s[24:27], s57 offen lds
    s_add_u32 s57, s57, 40960
    s_cmp_lt_u32 s57, 327680
    s_cbranch_scc1 concat_heads__mha_block__mha_block__prompt_kernel_hw2x
    s_lshl_b32 s36, s33, 4
    s_add_u32 s36, s36, s4
    s_lshl_b32 s36, s36, 1
    s_lshr_b32 s37, s5, 2
    s_add_u32 s36, s36, s37
    s_mul_i32 s36, s36, 81920
    s_and_b32 s37, s5, 3
    s_mul_i32 s37, s37, 5120
    s_add_u32 s36, s36, s37
    s_add_u32 s36, s36, 10485760
    v_lshl_add_u32 v2, v1, 7, s36
    v_cmp_gt_u32 vcc, 40, v1
    v_mov_b32 v3, 1073741824
    s_mov_b32 s41, 0
    s_mov_b32 s53, 262144
    v_cndmask_b32 v24, v3, v2, vcc
    s_waitcnt vmcnt(0)
    s_load_dwordx8 s[64:71], s[6:7], s40 glc
    s_mov_b32 s54, 0
    s_waitcnt lgkmcnt(0)
    s_cmp_eq_u32 s71, s61
    s_addc_u32 s54, s54, s54
    s_cmp_eq_u32 s70, s61
    s_addc_u32 s54, s54, s54
    s_cmp_eq_u32 s69, s61
    s_addc_u32 s54, s54, s54
    s_cmp_eq_u32 s68, s61
    s_addc_u32 s54, s54, s54
    s_cmp_eq_u32 s67, s61
    s_addc_u32 s54, s54, s54
    s_cmp_eq_u32 s66, s61
    s_addc_u32 s54, s54, s54
    s_cmp_eq_u32 s65, s61
    s_addc_u32 s54, s54, s54
    s_cmp_eq_u32 s64, s61
    s_addc_u32 s54, s54, s54
    s_sub_u32 s53, s53, 1
    s_cmp_eq_u32 s53, 0
    s_cselect_b32 s36, 0xff, s54
    s_lshr_b32 s37, s36, 1
    s_and_b32 s36, s36, s37
    s_and_b32 s52, s36, 0x55
    s_andn2_b32 s57, s52, s41
    s_or_b32 s41, s41, s52
    s_bitcmp1_b32 s57, 0
    s_cbranch_scc0 concat_heads__mha_block__mha_block__prompt_kernel_po0
    s_mov_b32 s36, 0
    buffer_load_dword v31, v24, s[16:19], s36 offen sc1
concat_heads__mha_block__mha_block__prompt_kernel_po0:
    s_bitcmp1_b32 s57, 2
    s_cbranch_scc0 concat_heads__mha_block__mha_block__prompt_kernel_po1
    s_mov_b32 s36, 20480
    buffer_load_dword v32, v24, s[16:19], s36 offen sc1
concat_heads__mha_block__mha_block__prompt_kernel_po1:
    s_bitcmp1_b32 s57, 4
    s_cbranch_scc0 concat_heads__mha_block__mha_block__prompt_kernel_po2
    s_mov_b32 s36, 40960
    buffer_load_dword v33, v24, s[16:19], s36 offen sc1
concat_heads__mha_block__mha_block__prompt_kernel_po2:
    s_bitcmp1_b32 s57, 6
    s_cbranch_scc0 concat_heads__mha_block__mha_block__prompt_kernel_po3
    s_mov_b32 s36, 61440
    buffer_load_dword v34, v24, s[16:19], s36 offen sc1
concat_heads__mha_block__mha_block__prompt_kernel_po3:
    v_mov_b32 v11, s52
    ds_write_b32 v25, v11
    s_barrier
concat_heads__mha_block__mha_block__prompt_kernel_p3l:
    s_load_dwordx8 s[64:71], s[6:7], s40 glc
    s_mov_b32 s54, 0
    s_waitcnt lgkmcnt(0)
    s_cmp_eq_u32 s71, s61
    s_addc_u32 s54, s54, s54
    s_cmp_eq_u32 s70, s61
    s_addc_u32 s54, s54, s54
    s_cmp_eq_u32 s69, s61
    s_addc_u32 s54, s54, s54
    s_cmp_eq_u32 s68, s61
    s_addc_u32 s54, s54, s54
    s_cmp_eq_u32 s67, s61
    s_addc_u32 s54, s54, s54
    s_cmp_eq_u32 s66, s61
    s_addc_u32 s54, s54, s54
    s_cmp_eq_u32 s65, s61
    s_addc_u32 s54, s54, s54
    s_cmp_eq_u32 s64, s61
    s_addc_u32 s54, s54, s54
    s_sub_u32 s53, s53, 1
    s_cmp_eq_u32 s53, 0
    s_cselect_b32 s36, 0xff, s54
    s_lshr_b32 s37, s36, 1
    s_and_b32 s36, s36, s37
    s_and_b32 s52, s36, 0x55
    s_andn2_b32 s57, s52, s41
    s_or_b32 s41, s41, s52
    s_bitcmp1_b32 s57, 0
    s_cbranch_scc0 concat_heads__mha_block__mha_block__prompt_kernel_po4
    s_mov_b32 s36, 0
    buffer_load_dword v31, v24, s[16:19], s36 offen sc1
concat_heads__mha_block__mha_block__prompt_kernel_po4:
    s_bitcmp1_b32 s57, 2
    s_cbranch_scc0 concat_heads__mha_block__mha_block__prompt_kernel_po5
    s_mov_b32 s36, 20480
    buffer_load_dword v32, v24, s[16:19], s36 offen sc1
concat_heads__mha_block__mha_block__prompt_kernel_po5:
    s_bitcmp1_b32 s57, 4
    s_cbranch_scc0 concat_heads__mha_block__mha_block__prompt_kernel_po6
    s_mov_b32 s36, 40960
    buffer_load_dword v33, v24, s[16:19], s36 offen sc1
concat_heads__mha_block__mha_block__prompt_kernel_po6:
    s_bitcmp1_b32 s57, 6
    s_cbranch_scc0 concat_heads__mha_block__mha_block__prompt_kernel_po7
    s_mov_b32 s36, 61440
    buffer_load_dword v34, v24, s[16:19], s36 offen sc1
concat_heads__mha_block__mha_block__prompt_kernel_po7:
    v_mov_b32 v11, s52
    ds_write_b32 v25, v11
    s_cmp_eq_u32 s52, 0x55
    s_cbranch_scc0 concat_heads__mha_block__mha_block__prompt_kernel_p3l
concat_heads__mha_block__mha_block__prompt_kernel_p3e:
    s_or_b32 s36, s4, s5
    s_cbranch_scc1 concat_heads__mha_block__mha_block__prompt_kernel_nb
    s_lshl_b32 s36, s33, 7
    s_add_u32 s36, s36, 15740928
    s_mov_b64 exec, 1
    v_mov_b32 v2, 0
    v_mov_b32 v3, s61
    buffer_store_dword v3, v2, s[16:19], s36 offen sc1
    s_mov_b64 exec, -1
concat_heads__mha_block__mha_block__prompt_kernel_nb:
    s_endpgm
concat_heads__mha_block__mha_block__prompt_kernel_end:
.section .rodata,"a"
.p2align 6
.amdhsa_kernel concat_heads__mha_block__mha_block__prompt_kernel
  .amdhsa_next_free_vgpr 168
  .amdhsa_next_free_sgpr 80
  .amdhsa_accum_offset 168
  .amdhsa_group_segment_fixed_size 0
  .amdhsa_kernarg_size 72
  .amdhsa_user_sgpr_count 2
  .amdhsa_user_sgpr_kernarg_segment_ptr 1
  .amdhsa_system_sgpr_workgroup_id_x 1
.end_amdhsa_kernel
```
